```python
import torch

def _softmax(x, axis=-1):
    return torch.softmax(x, dim=axis)
def _gelu(x):
    return torch.nn.functional.gelu(x, approximate="tanh")
def _silu(x):
    return torch.nn.functional.silu(x)
def _sigmoid(x):
    return torch.sigmoid(x)
def _layernorm(x, axis=-1, eps=1e-5):
    m = x.mean(dim=axis, keepdim=True)
    v = x.var(dim=axis, keepdim=True, unbiased=False)
    return (x - m) / torch.sqrt(v + eps)
def _scatter_add(tgt, idx, src, axis=0):
    return tgt.clone().index_add_(axis, idx, src)
def _segment_sum(src, seg, n):
    out = torch.zeros((n,) + src.shape[1:], dtype=src.dtype)
    return out.index_add_(0, seg, src)
def _pad(x, pw):
    flat = tuple(v for pair in reversed(pw) for v in pair)
    return torch.nn.functional.pad(x, flat)

kernel_name = 'gated_mix__mha_block_cached__geglu_ffn__decode'

def setup_inputs():

    _w = (lambda a: (lambda t: t.to(torch.bfloat16) if t.is_floating_point() else t)(torch.as_tensor(a)))
    def _A_setup():
        B, Sq, D = 4, 1, 512
        H, Sk, Dh = 32, 4096, 128
        return {
            "x": _w((lambda *s: torch.randn(*s, dtype=torch.bfloat16) * 0.05)(B, Sq, D)),
            "k_cache": _w((lambda *s: torch.randn(*s, dtype=torch.bfloat16) * 6.4)(B, H, Sk, Dh)),
            "v_cache": _w((lambda *s: torch.randn(*s, dtype=torch.bfloat16) * 0.2)(B, H, Sk, Dh)),
            "wq": _w((lambda *s: torch.randn(*s, dtype=torch.bfloat16) * 6.4)(D, H * Dh) * (D ** -0.5)),
            "wo": _w((lambda *s: torch.randn(*s, dtype=torch.bfloat16) * 0.2)(H * Dh, D) * ((H * Dh) ** -0.5)),
        }
    _A_in = _A_setup()

    def _B_setup():
        B, S, D, F = 4, 1, 512, 1792
        return {
            "x": _w((lambda *s: torch.randn(*s, dtype=torch.bfloat16) * 0.05)(B, S, D)),
            "w_gate": _w((lambda *s: torch.randn(*s, dtype=torch.bfloat16) * 0.05)(D, F)),
            "w_up": _w((lambda *s: torch.randn(*s, dtype=torch.bfloat16) * 0.05)(D, F)),
            "w_down": _w((lambda *s: torch.randn(*s, dtype=torch.bfloat16) * 0.05)(F, D)),
        }
    _B_in = _B_setup()

    return {
        "A_x": _A_in["x"],
        "A_k_cache": _A_in["k_cache"],
        "A_v_cache": _A_in["v_cache"],
        "A_wq": _A_in["wq"],
        "A_wo": _A_in["wo"],
        "B_x": _B_in["x"],
        "B_w_gate": _B_in["w_gate"],
        "B_w_up": _B_in["w_up"],
        "B_w_down": _B_in["w_down"],
        "gate_w": _w((lambda *s: torch.randn(*s, dtype=torch.bfloat16) * 0.05)(512) * 16.0),
    }

def reference(A_x, A_k_cache, A_v_cache, A_wq, A_wo, B_x, B_w_gate, B_w_up, B_w_down, gate_w):
    def _A_ref(x, k_cache, v_cache, wq, wo):
        B, Sq, D = x.shape
        H, Dh = 32, 128
        q = (lambda x, *d: x.permute(*d))((x @ wq).reshape(B, Sq, H, Dh), 0, 2, 1, 3)
        scores = torch.einsum("bhqd,bhkd->bhqk", q, k_cache) * (Dh ** -0.5)
        p = _softmax(scores, axis=-1)
        o = torch.einsum("bhqk,bhkd->bhqd", p, v_cache)
        return (lambda x, *d: x.permute(*d))(o, 0, 2, 1, 3).reshape(B, Sq, H * Dh) @ wo

    def _B_ref(x, w_gate, w_up, w_down):
        return (_gelu(x @ w_gate) * (x @ w_up)) @ w_down

    x = A_x
    g = _sigmoid((x * gate_w).sum(-1, keepdims=True))
    a = _A_ref(x, A_k_cache, A_v_cache, A_wq, A_wo)
    b = _B_ref(x, B_w_gate, B_w_up, B_w_down)
    return g * a + (1 - g) * b
```

```asm
; @launch grid=(256,1,1) block=(320,1,1) lds=8192
.amdgcn_target "amdgcn-amd-amdhsa--gfx950"
.text
.globl gated_mix__mha_block_cached__geglu_ffn__decode_kernel
.p2align 8
.type gated_mix__mha_block_cached__geglu_ffn__decode_kernel,@function
gated_mix__mha_block_cached__geglu_ffn__decode_kernel:
    s_cmp_ge_u32 s2, 256
    s_cbranch_scc1 L_END
    s_load_dwordx16 s[16:31], s[0:1], 0
    s_load_dwordx8 s[32:39], s[0:1], 64
    s_load_dwordx2 s[40:41], s[0:1], 96
    v_lshrrev_b32 v1, 6, v0
    s_nop 0
    v_readfirstlane_b32 s3, v1
    v_and_b32 v0, 63, v0
    s_and_b32 s42, s2, 7
    s_lshr_b32 s43, s2, 3
    s_and_b32 s45, s43, 7
    s_lshr_b32 s43, s43, 3
    s_and_b32 s44, s43, 1
    s_lshl_b32 s46, s42, 1
    s_or_b32 s44, s44, s46
    s_lshr_b32 s46, s43, 1
    s_lshl_b32 s46, s46, 4
    s_or_b32 s44, s44, s46
    s_lshr_b32 s46, s45, 1
    s_and_b32 s47, s45, 1
    s_cmp_eq_u32 s3, 4
    s_cbranch_scc1 L_AUX
L_ATT:
    s_setprio 2
    s_lshl_b32 s59, s46, 5
    s_add_u32 s59, s59, s44
    s_lshl_b32 s52, s59, 20
    s_lshl_b32 s59, s47, 19
    s_add_u32 s52, s52, s59
    s_mul_i32 s76, s3, 1024
    s_mov_b32 s53, s52
    s_movk_i32 s54, 0x1000
    v_lshrrev_b32 v52, 4, v0
    v_bfe_u32 v53, v0, 2, 2
    v_and_b32 v54, 3, v0
    v_lshlrev_b32 v1, 6, v52
    v_lshl_add_u32 v1, v53, 8, v1
    v_lshl_add_u32 v1, v54, 4, v1
    v_add_u32 v1, s76, v1
    s_waitcnt lgkmcnt(0)
    s_mov_b32 s4, s18
    s_and_b32 s5, s19, 0xffff
    s_mov_b32 s6, 0x8000000
    s_mov_b32 s7, 0x20000
    buffer_load_dwordx4 v[96:99], v1, s[4:7], s53 offen nt
    s_add_u32 s53, s53, s54
    buffer_load_dwordx4 v[100:103], v1, s[4:7], s53 offen nt
    s_add_u32 s53, s53, s54
    buffer_load_dwordx4 v[104:107], v1, s[4:7], s53 offen nt
    s_add_u32 s53, s53, s54
    buffer_load_dwordx4 v[108:111], v1, s[4:7], s53 offen nt
    s_add_u32 s53, s53, s54
    buffer_load_dwordx4 v[112:115], v1, s[4:7], s53 offen nt
    s_add_u32 s53, s53, s54
    buffer_load_dwordx4 v[116:119], v1, s[4:7], s53 offen nt
    s_add_u32 s53, s53, s54
    buffer_load_dwordx4 v[120:123], v1, s[4:7], s53 offen nt
    s_add_u32 s53, s53, s54
    buffer_load_dwordx4 v[124:127], v1, s[4:7], s53 offen nt
    s_add_u32 s53, s53, s54
    s_mov_b32 s8, s20
    s_and_b32 s9, s21, 0xffff
    s_mov_b32 s10, 0x8000000
    s_mov_b32 s11, 0x20000
    s_mov_b32 s12, s24
    s_and_b32 s13, s25, 0xffff
    s_mov_b32 s14, 0x400000
    s_mov_b32 s15, 0x20000
    s_mov_b32 s48, s40
    s_and_b32 s49, s41, 0xffff
    s_mov_b32 s50, 0x20000000
    s_mov_b32 s51, 0x20000
    s_mov_b32 s55, 0x3e0293ee
    s_mov_b32 s56, 0x5040100
    s_mov_b32 s57, 0x7060302
    s_lshl_b32 s58, s44, 17
    s_lshl_b32 s77, s44, 1
    s_add_u32 s77, s77, s47
    v_lshlrev_b32 v2, 4, v0
    v_add_u32 v2, s76, v2
    v_and_b32 v55, 15, v0
    s_lshl_b32 s59, s3, 8
    v_lshlrev_b32 v3, 13, v52
    v_lshl_add_u32 v3, v55, 4, v3
    v_add_u32 v3, s59, v3
    v_lshrrev_b32 v56, 1, v55
    v_and_b32 v57, 1, v0
    v_mov_b32 v58, 0xffff
    v_mov_b32 v59, 0xffff0000
    v_cmp_eq_u32 vcc, 1, v57
    s_nop 1
    v_cndmask_b32 v58, v58, v59, vcc
    v_cmp_eq_u32 vcc, 0, v56
    s_nop 1
    v_cndmask_b32 v4, 0, v58, vcc
    v_cmp_eq_u32 vcc, 1, v56
    s_nop 1
    v_cndmask_b32 v5, 0, v58, vcc
    v_cmp_eq_u32 vcc, 2, v56
    s_nop 1
    v_cndmask_b32 v6, 0, v58, vcc
    v_cmp_eq_u32 vcc, 3, v56
    s_nop 1
    v_cndmask_b32 v7, 0, v58, vcc
    v_cmp_eq_u32 s[60:61], 0, v53
    v_cmp_eq_u32 s[62:63], 1, v53
    v_cmp_eq_u32 s[64:65], 2, v53
    v_cmp_eq_u32 s[66:67], 3, v53
    v_lshlrev_b32 v60, 6, v52
    v_lshl_add_u32 v60, v54, 4, v60
    v_mov_b32 v8, 0
    v_mov_b32 v9, 0
    v_mov_b32 v10, 0
    v_mov_b32 v11, 0
    s_mov_b32 s16, 0
    s_mov_b32 s17, s16
    s_lshr_b32 s76, s2, 3
    s_mov_b32 s79, 0x7f
    s_bitcmp1_b32 s79, s76
    s_cselect_b32 s78, 0x55555555, 0
    s_cselect_b32 s79, 0x0, 0
    s_or_b32 s16, s16, s78
    s_or_b32 s17, s17, s79
    s_waitcnt vmcnt(4)
    buffer_load_dwordx4 v[128:131], v1, s[4:7], s53 offen nt
    s_add_u32 s53, s53, s54
    s_waitcnt vmcnt(4)
    buffer_load_dwordx4 v[132:135], v1, s[4:7], s53 offen nt
    s_add_u32 s53, s53, s54
    s_waitcnt vmcnt(4)
    buffer_load_dwordx4 v[136:139], v1, s[4:7], s53 offen nt
    s_add_u32 s53, s53, s54
    s_waitcnt vmcnt(4)
    buffer_load_dwordx4 v[140:143], v1, s[4:7], s53 offen nt
    s_add_u32 s53, s53, s54
    s_waitcnt vmcnt(4)
    buffer_load_dwordx4 v[144:147], v1, s[4:7], s53 offen nt
    s_add_u32 s53, s53, s54
    s_waitcnt vmcnt(4)
    buffer_load_dwordx4 v[148:151], v1, s[4:7], s53 offen nt
    s_add_u32 s53, s53, s54
    s_waitcnt vmcnt(4)
    buffer_load_dwordx4 v[152:155], v1, s[4:7], s53 offen nt
    s_add_u32 s53, s53, s54
    s_waitcnt vmcnt(4)
    buffer_load_dwordx4 v[156:159], v1, s[4:7], s53 offen nt
    s_add_u32 s53, s53, s54
    s_waitcnt vmcnt(4)
    buffer_load_dwordx4 v[160:163], v1, s[4:7], s53 offen nt
    s_add_u32 s53, s53, s54
    s_waitcnt vmcnt(4)
    buffer_load_dwordx4 v[164:167], v1, s[4:7], s53 offen nt
    s_add_u32 s53, s53, s54
    s_waitcnt vmcnt(4)
    buffer_load_dwordx4 v[168:171], v1, s[4:7], s53 offen nt
    s_add_u32 s53, s53, s54
    s_waitcnt vmcnt(4)
    buffer_load_dwordx4 v[172:175], v1, s[4:7], s53 offen nt
    s_add_u32 s53, s53, s54
    s_waitcnt vmcnt(4)
    buffer_load_dwordx4 v[176:179], v1, s[4:7], s53 offen nt
    s_add_u32 s53, s53, s54
    s_waitcnt vmcnt(4)
    buffer_load_dwordx4 v[180:183], v1, s[4:7], s53 offen nt
    s_add_u32 s53, s53, s54
    s_waitcnt vmcnt(4)
    buffer_load_dwordx4 v[184:187], v1, s[4:7], s53 offen nt
    s_add_u32 s53, s53, s54
    s_waitcnt vmcnt(4)
    buffer_load_dwordx4 v[188:191], v1, s[4:7], s53 offen nt
    s_add_u32 s53, s53, s54
    s_waitcnt vmcnt(4)
    buffer_load_dwordx4 v[192:195], v1, s[4:7], s53 offen nt
    s_add_u32 s53, s53, s54
    s_waitcnt vmcnt(4)
    buffer_load_dwordx4 v[196:199], v1, s[4:7], s53 offen nt
    s_add_u32 s53, s53, s54
    s_waitcnt vmcnt(4)
    buffer_load_dwordx4 v[200:203], v1, s[4:7], s53 offen nt
    s_add_u32 s53, s53, s54
    s_waitcnt vmcnt(4)
    buffer_load_dwordx4 v[204:207], v1, s[4:7], s53 offen nt
    s_add_u32 s53, s53, s54
    s_waitcnt vmcnt(4)
    buffer_load_dwordx4 v[208:211], v1, s[4:7], s53 offen nt
    s_add_u32 s53, s53, s54
    s_waitcnt vmcnt(4)
    buffer_load_dwordx4 v[212:215], v1, s[4:7], s53 offen nt
    s_add_u32 s53, s53, s54
    s_waitcnt vmcnt(4)
    buffer_load_dwordx4 v[216:219], v1, s[4:7], s53 offen nt
    s_add_u32 s53, s53, s54
    s_waitcnt vmcnt(4)
    buffer_load_dwordx4 v[220:223], v1, s[4:7], s53 offen nt
    s_add_u32 s53, s53, s54
    s_waitcnt vmcnt(4)
    buffer_load_dwordx4 v[224:227], v1, s[4:7], s53 offen nt
    s_add_u32 s53, s53, s54
    s_waitcnt vmcnt(4)
    buffer_load_dwordx4 v[228:231], v1, s[4:7], s53 offen nt
    s_add_u32 s53, s53, s54
    s_waitcnt vmcnt(4)
    buffer_load_dwordx4 v[232:235], v1, s[4:7], s53 offen nt
    s_add_u32 s53, s53, s54
    s_waitcnt vmcnt(4)
    buffer_load_dwordx4 v[236:239], v1, s[4:7], s53 offen nt
    s_add_u32 s53, s53, s54
    s_waitcnt vmcnt(4)
    buffer_load_dwordx4 v[240:243], v1, s[4:7], s53 offen nt
    s_add_u32 s53, s53, s54
    s_waitcnt vmcnt(4)
    buffer_load_dwordx4 v[244:247], v1, s[4:7], s53 offen nt
    s_add_u32 s53, s53, s54
    s_waitcnt vmcnt(4)
    buffer_load_dwordx4 v[248:251], v1, s[4:7], s53 offen nt
    s_add_u32 s53, s53, s54
    s_waitcnt vmcnt(4)
    buffer_load_dwordx4 v[252:255], v1, s[4:7], s53 offen nt
    s_add_u32 s53, s53, s54
    s_barrier
    ds_read_b128 v[56:59], v60 offset:0
    s_waitcnt lgkmcnt(0)
    v_cndmask_b32_e64 v64, 0, v56, s[60:61]
    v_cndmask_b32_e64 v65, 0, v57, s[60:61]
    v_cndmask_b32_e64 v66, 0, v58, s[60:61]
    v_cndmask_b32_e64 v67, 0, v59, s[60:61]
    v_cndmask_b32_e64 v68, 0, v56, s[62:63]
    v_cndmask_b32_e64 v69, 0, v57, s[62:63]
    v_cndmask_b32_e64 v70, 0, v58, s[62:63]
    v_cndmask_b32_e64 v71, 0, v59, s[62:63]
    v_cndmask_b32_e64 v72, 0, v56, s[64:65]
    v_cndmask_b32_e64 v73, 0, v57, s[64:65]
    v_cndmask_b32_e64 v74, 0, v58, s[64:65]
    v_cndmask_b32_e64 v75, 0, v59, s[64:65]
    v_cndmask_b32_e64 v76, 0, v56, s[66:67]
    v_cndmask_b32_e64 v77, 0, v57, s[66:67]
    v_cndmask_b32_e64 v78, 0, v58, s[66:67]
    v_cndmask_b32_e64 v79, 0, v59, s[66:67]
    s_bitcmp1_b32 s16, 8
    s_cbranch_scc1 L_PACE40
    s_waitcnt vmcnt(4)
L_PACE40:
    buffer_load_dwordx4 v[80:83], v1, s[4:7], s53 offen nt
    s_add_u32 s53, s53, s54
    v_mfma_f32_16x16x32_bf16 v[12:15], v[96:99], v[64:67], 0
    v_mfma_f32_16x16x32_bf16 v[12:15], v[100:103], v[68:71], v[12:15]
    v_mfma_f32_16x16x32_bf16 v[12:15], v[104:107], v[72:75], v[12:15]
    s_waitcnt vmcnt(5)
    s_bitcmp1_b32 s16, 9
    s_cbranch_scc1 L_PACE41
    s_waitcnt vmcnt(4)
L_PACE41:
    buffer_load_dwordx4 v[96:99], v1, s[4:7], s53 offen nt
    s_add_u32 s53, s53, s54
    v_mfma_f32_16x16x32_bf16 v[12:15], v[108:111], v[76:79], v[12:15]
    v_mfma_f32_16x16x32_bf16 v[16:19], v[112:115], v[64:67], 0
    v_mfma_f32_16x16x32_bf16 v[16:19], v[116:119], v[68:71], v[16:19]
    s_nop 5
    v_mov_b32_dpp v20, v12 quad_perm:[0,0,0,0] row_mask:0xf bank_mask:0xf
    v_mov_b32_dpp v52, v14 quad_perm:[2,2,2,2] row_mask:0xf bank_mask:0xf
    s_nop 0
    v_add_f32_dpp v20, v13, v20 quad_perm:[1,1,1,1] row_mask:0xf bank_mask:0xf
    v_add_f32_dpp v52, v15, v52 quad_perm:[3,3,3,3] row_mask:0xf bank_mask:0xf
    v_add_f32 v20, v20, v52
    s_waitcnt vmcnt(5)
    s_bitcmp1_b32 s16, 10
    s_cbranch_scc1 L_PACE42
    s_waitcnt vmcnt(4)
L_PACE42:
    buffer_load_dwordx4 v[100:103], v1, s[4:7], s53 offen nt
    s_add_u32 s53, s53, s54
    v_mfma_f32_16x16x32_bf16 v[16:19], v[120:123], v[72:75], v[16:19]
    v_mfma_f32_16x16x32_bf16 v[16:19], v[124:127], v[76:79], v[16:19]
    v_mfma_f32_16x16x32_bf16 v[12:15], v[128:131], v[64:67], 0
    s_waitcnt vmcnt(5)
    s_bitcmp1_b32 s16, 11
    s_cbranch_scc1 L_PACE43
    s_waitcnt vmcnt(4)
L_PACE43:
    buffer_load_dwordx4 v[104:107], v1, s[4:7], s53 offen nt
    s_add_u32 s53, s53, s54
    v_mfma_f32_16x16x32_bf16 v[12:15], v[132:135], v[68:71], v[12:15]
    s_nop 0
    v_mov_b32_dpp v21, v16 quad_perm:[0,0,0,0] row_mask:0xf bank_mask:0xf
    v_mov_b32_dpp v52, v18 quad_perm:[2,2,2,2] row_mask:0xf bank_mask:0xf
    s_nop 0
    v_add_f32_dpp v21, v17, v21 quad_perm:[1,1,1,1] row_mask:0xf bank_mask:0xf
    v_add_f32_dpp v52, v19, v52 quad_perm:[3,3,3,3] row_mask:0xf bank_mask:0xf
    v_add_f32 v21, v21, v52
    v_mfma_f32_16x16x32_bf16 v[12:15], v[136:139], v[72:75], v[12:15]
    v_mfma_f32_16x16x32_bf16 v[12:15], v[140:143], v[76:79], v[12:15]
    s_waitcnt vmcnt(5)
    s_bitcmp1_b32 s16, 12
    s_cbranch_scc1 L_PACE44
    s_waitcnt vmcnt(4)
L_PACE44:
    buffer_load_dwordx4 v[108:111], v1, s[4:7], s53 offen nt
    s_add_u32 s53, s53, s54
    v_mfma_f32_16x16x32_bf16 v[16:19], v[144:147], v[64:67], 0
    v_mfma_f32_16x16x32_bf16 v[16:19], v[148:151], v[68:71], v[16:19]
    s_nop 0
    v_mov_b32_dpp v22, v12 quad_perm:[0,0,0,0] row_mask:0xf bank_mask:0xf
    v_mov_b32_dpp v52, v14 quad_perm:[2,2,2,2] row_mask:0xf bank_mask:0xf
    s_nop 0
    v_add_f32_dpp v22, v13, v22 quad_perm:[1,1,1,1] row_mask:0xf bank_mask:0xf
    v_add_f32_dpp v52, v15, v52 quad_perm:[3,3,3,3] row_mask:0xf bank_mask:0xf
    v_add_f32 v22, v22, v52
    v_mfma_f32_16x16x32_bf16 v[16:19], v[152:155], v[72:75], v[16:19]
    s_waitcnt vmcnt(5)
    s_bitcmp1_b32 s16, 13
    s_cbranch_scc1 L_PACE45
    s_waitcnt vmcnt(4)
L_PACE45:
    buffer_load_dwordx4 v[112:115], v1, s[4:7], s53 offen nt
    s_add_u32 s53, s53, s54
    v_mfma_f32_16x16x32_bf16 v[16:19], v[156:159], v[76:79], v[16:19]
    v_mfma_f32_16x16x32_bf16 v[12:15], v[160:163], v[64:67], 0
    v_mfma_f32_16x16x32_bf16 v[12:15], v[164:167], v[68:71], v[12:15]
    s_nop 5
    v_mov_b32_dpp v23, v16 quad_perm:[0,0,0,0] row_mask:0xf bank_mask:0xf
    v_mov_b32_dpp v52, v18 quad_perm:[2,2,2,2] row_mask:0xf bank_mask:0xf
    s_nop 0
    v_add_f32_dpp v23, v17, v23 quad_perm:[1,1,1,1] row_mask:0xf bank_mask:0xf
    v_add_f32_dpp v52, v19, v52 quad_perm:[3,3,3,3] row_mask:0xf bank_mask:0xf
    v_add_f32 v23, v23, v52
    s_waitcnt vmcnt(5)
    s_bitcmp1_b32 s16, 14
    s_cbranch_scc1 L_PACE46
    s_waitcnt vmcnt(4)
L_PACE46:
    buffer_load_dwordx4 v[116:119], v1, s[4:7], s53 offen nt
    s_add_u32 s53, s53, s54
    v_mfma_f32_16x16x32_bf16 v[12:15], v[168:171], v[72:75], v[12:15]
    v_mfma_f32_16x16x32_bf16 v[12:15], v[172:175], v[76:79], v[12:15]
    v_mfma_f32_16x16x32_bf16 v[16:19], v[176:179], v[64:67], 0
    s_waitcnt vmcnt(5)
    s_bitcmp1_b32 s16, 15
    s_cbranch_scc1 L_PACE47
    s_waitcnt vmcnt(4)
L_PACE47:
    buffer_load_dwordx4 v[120:123], v1, s[4:7], s53 offen nt
    s_add_u32 s53, s53, s54
    v_mfma_f32_16x16x32_bf16 v[16:19], v[180:183], v[68:71], v[16:19]
    s_nop 0
    v_mov_b32_dpp v24, v12 quad_perm:[0,0,0,0] row_mask:0xf bank_mask:0xf
    v_mov_b32_dpp v52, v14 quad_perm:[2,2,2,2] row_mask:0xf bank_mask:0xf
    s_nop 0
    v_add_f32_dpp v24, v13, v24 quad_perm:[1,1,1,1] row_mask:0xf bank_mask:0xf
    v_add_f32_dpp v52, v15, v52 quad_perm:[3,3,3,3] row_mask:0xf bank_mask:0xf
    v_add_f32 v24, v24, v52
    v_mfma_f32_16x16x32_bf16 v[16:19], v[184:187], v[72:75], v[16:19]
    v_mfma_f32_16x16x32_bf16 v[16:19], v[188:191], v[76:79], v[16:19]
    s_waitcnt vmcnt(5)
    s_bitcmp1_b32 s16, 16
    s_cbranch_scc1 L_PACE48
    s_waitcnt vmcnt(4)
L_PACE48:
    buffer_load_dwordx4 v[124:127], v1, s[4:7], s53 offen nt
    s_add_u32 s53, s53, s54
    v_mfma_f32_16x16x32_bf16 v[12:15], v[192:195], v[64:67], 0
    v_mfma_f32_16x16x32_bf16 v[12:15], v[196:199], v[68:71], v[12:15]
    s_nop 0
    v_mov_b32_dpp v25, v16 quad_perm:[0,0,0,0] row_mask:0xf bank_mask:0xf
    v_mov_b32_dpp v52, v18 quad_perm:[2,2,2,2] row_mask:0xf bank_mask:0xf
    s_nop 0
    v_add_f32_dpp v25, v17, v25 quad_perm:[1,1,1,1] row_mask:0xf bank_mask:0xf
    v_add_f32_dpp v52, v19, v52 quad_perm:[3,3,3,3] row_mask:0xf bank_mask:0xf
    v_add_f32 v25, v25, v52
    v_mfma_f32_16x16x32_bf16 v[12:15], v[200:203], v[72:75], v[12:15]
    s_waitcnt vmcnt(5)
    s_bitcmp1_b32 s16, 17
    s_cbranch_scc1 L_PACE49
    s_waitcnt vmcnt(4)
L_PACE49:
    buffer_load_dwordx4 v[128:131], v1, s[4:7], s53 offen nt
    s_add_u32 s53, s53, s54
    v_mfma_f32_16x16x32_bf16 v[12:15], v[204:207], v[76:79], v[12:15]
    v_mfma_f32_16x16x32_bf16 v[16:19], v[208:211], v[64:67], 0
    v_mfma_f32_16x16x32_bf16 v[16:19], v[212:215], v[68:71], v[16:19]
    s_nop 5
    v_mov_b32_dpp v26, v12 quad_perm:[0,0,0,0] row_mask:0xf bank_mask:0xf
    v_mov_b32_dpp v52, v14 quad_perm:[2,2,2,2] row_mask:0xf bank_mask:0xf
    s_nop 0
    v_add_f32_dpp v26, v13, v26 quad_perm:[1,1,1,1] row_mask:0xf bank_mask:0xf
    v_add_f32_dpp v52, v15, v52 quad_perm:[3,3,3,3] row_mask:0xf bank_mask:0xf
    v_add_f32 v26, v26, v52
    s_waitcnt vmcnt(5)
    s_bitcmp1_b32 s16, 18
    s_cbranch_scc1 L_PACE50
    s_waitcnt vmcnt(4)
L_PACE50:
    buffer_load_dwordx4 v[132:135], v1, s[4:7], s53 offen nt
    s_add_u32 s53, s53, s54
    v_mfma_f32_16x16x32_bf16 v[16:19], v[216:219], v[72:75], v[16:19]
    v_mfma_f32_16x16x32_bf16 v[16:19], v[220:223], v[76:79], v[16:19]
    v_mfma_f32_16x16x32_bf16 v[12:15], v[224:227], v[64:67], 0
    s_waitcnt vmcnt(5)
    s_bitcmp1_b32 s16, 19
    s_cbranch_scc1 L_PACE51
    s_waitcnt vmcnt(4)
L_PACE51:
    buffer_load_dwordx4 v[136:139], v1, s[4:7], s53 offen nt
    s_add_u32 s53, s53, s54
    v_mfma_f32_16x16x32_bf16 v[12:15], v[228:231], v[68:71], v[12:15]
    s_nop 0
    v_mov_b32_dpp v27, v16 quad_perm:[0,0,0,0] row_mask:0xf bank_mask:0xf
    v_mov_b32_dpp v52, v18 quad_perm:[2,2,2,2] row_mask:0xf bank_mask:0xf
    s_nop 0
    v_add_f32_dpp v27, v17, v27 quad_perm:[1,1,1,1] row_mask:0xf bank_mask:0xf
    v_add_f32_dpp v52, v19, v52 quad_perm:[3,3,3,3] row_mask:0xf bank_mask:0xf
    v_add_f32 v27, v27, v52
    v_mfma_f32_16x16x32_bf16 v[12:15], v[232:235], v[72:75], v[12:15]
    v_mfma_f32_16x16x32_bf16 v[12:15], v[236:239], v[76:79], v[12:15]
    s_waitcnt vmcnt(5)
    s_bitcmp1_b32 s16, 20
    s_cbranch_scc1 L_PACE52
    s_waitcnt vmcnt(4)
L_PACE52:
    buffer_load_dwordx4 v[140:143], v1, s[4:7], s53 offen nt
    s_add_u32 s53, s53, s54
    v_mfma_f32_16x16x32_bf16 v[16:19], v[240:243], v[64:67], 0
    v_mfma_f32_16x16x32_bf16 v[16:19], v[244:247], v[68:71], v[16:19]
    s_nop 0
    v_mov_b32_dpp v28, v12 quad_perm:[0,0,0,0] row_mask:0xf bank_mask:0xf
    v_mov_b32_dpp v52, v14 quad_perm:[2,2,2,2] row_mask:0xf bank_mask:0xf
    s_nop 0
    v_add_f32_dpp v28, v13, v28 quad_perm:[1,1,1,1] row_mask:0xf bank_mask:0xf
    v_add_f32_dpp v52, v15, v52 quad_perm:[3,3,3,3] row_mask:0xf bank_mask:0xf
    v_add_f32 v28, v28, v52
    v_mfma_f32_16x16x32_bf16 v[16:19], v[248:251], v[72:75], v[16:19]
    s_waitcnt vmcnt(5)
    s_bitcmp1_b32 s16, 21
    s_cbranch_scc1 L_PACE53
    s_waitcnt vmcnt(4)
L_PACE53:
    buffer_load_dwordx4 v[144:147], v1, s[4:7], s53 offen nt
    s_add_u32 s53, s53, s54
    v_mfma_f32_16x16x32_bf16 v[16:19], v[252:255], v[76:79], v[16:19]
    v_mfma_f32_16x16x32_bf16 v[12:15], v[80:83], v[64:67], 0
    v_mfma_f32_16x16x32_bf16 v[12:15], v[96:99], v[68:71], v[12:15]
    s_nop 5
    v_mov_b32_dpp v29, v16 quad_perm:[0,0,0,0] row_mask:0xf bank_mask:0xf
    v_mov_b32_dpp v52, v18 quad_perm:[2,2,2,2] row_mask:0xf bank_mask:0xf
    s_nop 0
    v_add_f32_dpp v29, v17, v29 quad_perm:[1,1,1,1] row_mask:0xf bank_mask:0xf
    v_add_f32_dpp v52, v19, v52 quad_perm:[3,3,3,3] row_mask:0xf bank_mask:0xf
    v_add_f32 v29, v29, v52
    s_waitcnt vmcnt(5)
    s_bitcmp1_b32 s16, 22
    s_cbranch_scc1 L_PACE54
    s_waitcnt vmcnt(4)
L_PACE54:
    buffer_load_dwordx4 v[96:99], v1, s[4:7], s53 offen nt
    s_add_u32 s53, s53, s54
    v_mfma_f32_16x16x32_bf16 v[12:15], v[100:103], v[72:75], v[12:15]
    v_mfma_f32_16x16x32_bf16 v[12:15], v[104:107], v[76:79], v[12:15]
    v_mfma_f32_16x16x32_bf16 v[16:19], v[108:111], v[64:67], 0
    s_waitcnt vmcnt(5)
    s_bitcmp1_b32 s16, 23
    s_cbranch_scc1 L_PACE55
    s_waitcnt vmcnt(4)
L_PACE55:
    buffer_load_dwordx4 v[100:103], v1, s[4:7], s53 offen nt
    s_add_u32 s53, s53, s54
    v_mfma_f32_16x16x32_bf16 v[16:19], v[112:115], v[68:71], v[16:19]
    s_nop 0
    v_mov_b32_dpp v30, v12 quad_perm:[0,0,0,0] row_mask:0xf bank_mask:0xf
    v_mov_b32_dpp v52, v14 quad_perm:[2,2,2,2] row_mask:0xf bank_mask:0xf
    s_nop 0
    v_add_f32_dpp v30, v13, v30 quad_perm:[1,1,1,1] row_mask:0xf bank_mask:0xf
    v_add_f32_dpp v52, v15, v52 quad_perm:[3,3,3,3] row_mask:0xf bank_mask:0xf
    v_add_f32 v30, v30, v52
    v_mfma_f32_16x16x32_bf16 v[16:19], v[116:119], v[72:75], v[16:19]
    v_mfma_f32_16x16x32_bf16 v[16:19], v[120:123], v[76:79], v[16:19]
    s_waitcnt vmcnt(5)
    s_bitcmp1_b32 s16, 24
    s_cbranch_scc1 L_PACE56
    s_waitcnt vmcnt(4)
L_PACE56:
    buffer_load_dwordx4 v[104:107], v1, s[4:7], s53 offen nt
    s_add_u32 s53, s53, s54
    v_mfma_f32_16x16x32_bf16 v[12:15], v[124:127], v[64:67], 0
    v_mfma_f32_16x16x32_bf16 v[12:15], v[128:131], v[68:71], v[12:15]
    s_nop 0
    v_mov_b32_dpp v31, v16 quad_perm:[0,0,0,0] row_mask:0xf bank_mask:0xf
    v_mov_b32_dpp v52, v18 quad_perm:[2,2,2,2] row_mask:0xf bank_mask:0xf
    s_nop 0
    v_add_f32_dpp v31, v17, v31 quad_perm:[1,1,1,1] row_mask:0xf bank_mask:0xf
    v_add_f32_dpp v52, v19, v52 quad_perm:[3,3,3,3] row_mask:0xf bank_mask:0xf
    v_add_f32 v31, v31, v52
    v_mfma_f32_16x16x32_bf16 v[12:15], v[132:135], v[72:75], v[12:15]
    s_waitcnt vmcnt(5)
    s_bitcmp1_b32 s16, 25
    s_cbranch_scc1 L_PACE57
    s_waitcnt vmcnt(4)
L_PACE57:
    buffer_load_dwordx4 v[108:111], v1, s[4:7], s53 offen nt
    s_add_u32 s53, s53, s54
    v_mfma_f32_16x16x32_bf16 v[12:15], v[136:139], v[76:79], v[12:15]
    s_waitcnt vmcnt(5)
    v_mfma_f32_16x16x32_bf16 v[16:19], v[140:143], v[64:67], 0
    s_bitcmp1_b32 s16, 26
    s_cbranch_scc1 L_PACE58
    s_waitcnt vmcnt(4)
L_PACE58:
    buffer_load_dwordx4 v[112:115], v1, s[4:7], s53 offen nt
    s_add_u32 s53, s53, s54
    s_waitcnt vmcnt(5)
    v_mfma_f32_16x16x32_bf16 v[16:19], v[144:147], v[68:71], v[16:19]
    v_mov_b32_dpp v32, v12 quad_perm:[0,0,0,0] row_mask:0xf bank_mask:0xf
    v_mov_b32_dpp v52, v14 quad_perm:[2,2,2,2] row_mask:0xf bank_mask:0xf
    s_nop 0
    v_add_f32_dpp v32, v13, v32 quad_perm:[1,1,1,1] row_mask:0xf bank_mask:0xf
    v_add_f32_dpp v52, v15, v52 quad_perm:[3,3,3,3] row_mask:0xf bank_mask:0xf
    v_add_f32 v32, v32, v52
    s_bitcmp1_b32 s16, 27
    s_cbranch_scc1 L_PACE59
    s_waitcnt vmcnt(4)
L_PACE59:
    buffer_load_dwordx4 v[116:119], v1, s[4:7], s53 offen nt
    s_add_u32 s53, s53, s54
    s_waitcnt vmcnt(5)
    v_mfma_f32_16x16x32_bf16 v[16:19], v[96:99], v[72:75], v[16:19]
    s_bitcmp1_b32 s16, 28
    s_cbranch_scc1 L_PACE60
    s_waitcnt vmcnt(4)
L_PACE60:
    buffer_load_dwordx4 v[120:123], v1, s[4:7], s53 offen nt
    s_add_u32 s53, s53, s54
    s_waitcnt vmcnt(5)
    v_mfma_f32_16x16x32_bf16 v[16:19], v[100:103], v[76:79], v[16:19]
    s_bitcmp1_b32 s16, 29
    s_cbranch_scc1 L_PACE61
    s_waitcnt vmcnt(4)
L_PACE61:
    buffer_load_dwordx4 v[124:127], v1, s[4:7], s53 offen nt
    s_add_u32 s53, s53, s54
    s_waitcnt vmcnt(5)
    v_mfma_f32_16x16x32_bf16 v[12:15], v[104:107], v[64:67], 0
    s_bitcmp1_b32 s16, 30
    s_cbranch_scc1 L_PACE62
    s_waitcnt vmcnt(4)
L_PACE62:
    buffer_load_dwordx4 v[96:99], v1, s[4:7], s53 offen nt
    s_add_u32 s53, s53, s54
    s_waitcnt vmcnt(5)
    v_mfma_f32_16x16x32_bf16 v[12:15], v[108:111], v[68:71], v[12:15]
    v_mov_b32_dpp v33, v16 quad_perm:[0,0,0,0] row_mask:0xf bank_mask:0xf
    v_mov_b32_dpp v52, v18 quad_perm:[2,2,2,2] row_mask:0xf bank_mask:0xf
    s_nop 0
    v_add_f32_dpp v33, v17, v33 quad_perm:[1,1,1,1] row_mask:0xf bank_mask:0xf
    v_add_f32_dpp v52, v19, v52 quad_perm:[3,3,3,3] row_mask:0xf bank_mask:0xf
    v_add_f32 v33, v33, v52
    s_bitcmp1_b32 s16, 31
    s_cbranch_scc1 L_PACE63
    s_waitcnt vmcnt(4)
L_PACE63:
    buffer_load_dwordx4 v[100:103], v1, s[4:7], s53 offen nt
    s_add_u32 s53, s53, s54
    s_waitcnt vmcnt(5)
    v_mfma_f32_16x16x32_bf16 v[12:15], v[112:115], v[72:75], v[12:15]
    s_bitcmp1_b32 s16, 0
    s_cbranch_scc1 L_PACE64
    s_waitcnt vmcnt(4)
L_PACE64:
    buffer_load_dwordx4 v[104:107], v1, s[4:7], s53 offen nt
    s_add_u32 s53, s53, s54
    s_waitcnt vmcnt(5)
    v_mfma_f32_16x16x32_bf16 v[12:15], v[116:119], v[76:79], v[12:15]
    s_bitcmp1_b32 s16, 1
    s_cbranch_scc1 L_PACE65
    s_waitcnt vmcnt(4)
L_PACE65:
    buffer_load_dwordx4 v[108:111], v1, s[4:7], s53 offen nt
    s_add_u32 s53, s53, s54
    s_waitcnt vmcnt(5)
    v_mfma_f32_16x16x32_bf16 v[16:19], v[120:123], v[64:67], 0
    s_bitcmp1_b32 s16, 2
    s_cbranch_scc1 L_PACE66
    s_waitcnt vmcnt(4)
L_PACE66:
    buffer_load_dwordx4 v[112:115], v1, s[4:7], s53 offen nt
    s_add_u32 s53, s53, s54
    s_waitcnt vmcnt(5)
    v_mfma_f32_16x16x32_bf16 v[16:19], v[124:127], v[68:71], v[16:19]
    v_mov_b32_dpp v34, v12 quad_perm:[0,0,0,0] row_mask:0xf bank_mask:0xf
    v_mov_b32_dpp v52, v14 quad_perm:[2,2,2,2] row_mask:0xf bank_mask:0xf
    s_nop 0
    v_add_f32_dpp v34, v13, v34 quad_perm:[1,1,1,1] row_mask:0xf bank_mask:0xf
    v_add_f32_dpp v52, v15, v52 quad_perm:[3,3,3,3] row_mask:0xf bank_mask:0xf
    v_add_f32 v34, v34, v52
    s_bitcmp1_b32 s16, 3
    s_cbranch_scc1 L_PACE67
    s_waitcnt vmcnt(4)
L_PACE67:
    buffer_load_dwordx4 v[116:119], v1, s[4:7], s53 offen nt
    s_add_u32 s53, s53, s54
    s_waitcnt vmcnt(5)
    v_mfma_f32_16x16x32_bf16 v[16:19], v[96:99], v[72:75], v[16:19]
    s_bitcmp1_b32 s16, 4
    s_cbranch_scc1 L_PACE68
    s_waitcnt vmcnt(4)
L_PACE68:
    buffer_load_dwordx4 v[120:123], v1, s[4:7], s53 offen nt
    s_add_u32 s53, s53, s54
    s_waitcnt vmcnt(5)
    v_mfma_f32_16x16x32_bf16 v[16:19], v[100:103], v[76:79], v[16:19]
    s_bitcmp1_b32 s16, 5
    s_cbranch_scc1 L_PACE69
    s_waitcnt vmcnt(4)
L_PACE69:
    buffer_load_dwordx4 v[124:127], v1, s[4:7], s53 offen nt
    s_add_u32 s53, s53, s54
    s_waitcnt vmcnt(5)
    v_mfma_f32_16x16x32_bf16 v[12:15], v[104:107], v[64:67], 0
    s_bitcmp1_b32 s16, 6
    s_cbranch_scc1 L_PACE70
    s_waitcnt vmcnt(4)
L_PACE70:
    buffer_load_dwordx4 v[96:99], v1, s[4:7], s53 offen nt
    s_add_u32 s53, s53, s54
    s_waitcnt vmcnt(5)
    v_mfma_f32_16x16x32_bf16 v[12:15], v[108:111], v[68:71], v[12:15]
    v_mov_b32_dpp v35, v16 quad_perm:[0,0,0,0] row_mask:0xf bank_mask:0xf
    v_mov_b32_dpp v52, v18 quad_perm:[2,2,2,2] row_mask:0xf bank_mask:0xf
    s_nop 0
    v_add_f32_dpp v35, v17, v35 quad_perm:[1,1,1,1] row_mask:0xf bank_mask:0xf
    v_add_f32_dpp v52, v19, v52 quad_perm:[3,3,3,3] row_mask:0xf bank_mask:0xf
    v_add_f32 v35, v35, v52
    s_bitcmp1_b32 s16, 7
    s_cbranch_scc1 L_PACE71
    s_waitcnt vmcnt(4)
L_PACE71:
    buffer_load_dwordx4 v[100:103], v1, s[4:7], s53 offen nt
    s_add_u32 s53, s53, s54
    s_waitcnt vmcnt(5)
    v_mfma_f32_16x16x32_bf16 v[12:15], v[112:115], v[72:75], v[12:15]
    s_bitcmp1_b32 s16, 8
    s_cbranch_scc1 L_PACE72
    s_waitcnt vmcnt(4)
L_PACE72:
    buffer_load_dwordx4 v[104:107], v1, s[4:7], s53 offen nt
    s_add_u32 s53, s53, s54
    s_waitcnt vmcnt(5)
    v_mfma_f32_16x16x32_bf16 v[12:15], v[116:119], v[76:79], v[12:15]
    s_bitcmp1_b32 s16, 9
    s_cbranch_scc1 L_PACE73
    s_waitcnt vmcnt(4)
L_PACE73:
    buffer_load_dwordx4 v[108:111], v1, s[4:7], s53 offen nt
    s_add_u32 s53, s53, s54
    s_waitcnt vmcnt(5)
    v_mfma_f32_16x16x32_bf16 v[16:19], v[120:123], v[64:67], 0
    s_bitcmp1_b32 s16, 10
    s_cbranch_scc1 L_PACE74
    s_waitcnt vmcnt(4)
L_PACE74:
    buffer_load_dwordx4 v[112:115], v1, s[4:7], s53 offen nt
    s_add_u32 s53, s53, s54
    s_waitcnt vmcnt(5)
    v_mfma_f32_16x16x32_bf16 v[16:19], v[124:127], v[68:71], v[16:19]
    v_mov_b32_dpp v36, v12 quad_perm:[0,0,0,0] row_mask:0xf bank_mask:0xf
    v_mov_b32_dpp v52, v14 quad_perm:[2,2,2,2] row_mask:0xf bank_mask:0xf
    s_nop 0
    v_add_f32_dpp v36, v13, v36 quad_perm:[1,1,1,1] row_mask:0xf bank_mask:0xf
    v_add_f32_dpp v52, v15, v52 quad_perm:[3,3,3,3] row_mask:0xf bank_mask:0xf
    v_add_f32 v36, v36, v52
    s_bitcmp1_b32 s16, 11
    s_cbranch_scc1 L_PACE75
    s_waitcnt vmcnt(4)
L_PACE75:
    buffer_load_dwordx4 v[116:119], v1, s[4:7], s53 offen nt
    s_add_u32 s53, s53, s54
    s_waitcnt vmcnt(5)
    v_mfma_f32_16x16x32_bf16 v[16:19], v[96:99], v[72:75], v[16:19]
    s_bitcmp1_b32 s16, 12
    s_cbranch_scc1 L_PACE76
    s_waitcnt vmcnt(4)
L_PACE76:
    buffer_load_dwordx4 v[120:123], v1, s[4:7], s53 offen nt
    s_add_u32 s53, s53, s54
    s_waitcnt vmcnt(5)
    v_mfma_f32_16x16x32_bf16 v[16:19], v[100:103], v[76:79], v[16:19]
    s_bitcmp1_b32 s16, 13
    s_cbranch_scc1 L_PACE77
    s_waitcnt vmcnt(4)
L_PACE77:
    buffer_load_dwordx4 v[124:127], v1, s[4:7], s53 offen nt
    s_add_u32 s53, s53, s54
    s_waitcnt vmcnt(5)
    v_mfma_f32_16x16x32_bf16 v[12:15], v[104:107], v[64:67], 0
    s_bitcmp1_b32 s16, 14
    s_cbranch_scc1 L_PACE78
    s_waitcnt vmcnt(4)
L_PACE78:
    buffer_load_dwordx4 v[96:99], v1, s[4:7], s53 offen nt
    s_add_u32 s53, s53, s54
    s_waitcnt vmcnt(5)
    v_mfma_f32_16x16x32_bf16 v[12:15], v[108:111], v[68:71], v[12:15]
    v_mov_b32_dpp v37, v16 quad_perm:[0,0,0,0] row_mask:0xf bank_mask:0xf
    v_mov_b32_dpp v52, v18 quad_perm:[2,2,2,2] row_mask:0xf bank_mask:0xf
    s_nop 0
    v_add_f32_dpp v37, v17, v37 quad_perm:[1,1,1,1] row_mask:0xf bank_mask:0xf
    v_add_f32_dpp v52, v19, v52 quad_perm:[3,3,3,3] row_mask:0xf bank_mask:0xf
    v_add_f32 v37, v37, v52
    s_bitcmp1_b32 s16, 15
    s_cbranch_scc1 L_PACE79
    s_waitcnt vmcnt(4)
L_PACE79:
    buffer_load_dwordx4 v[100:103], v1, s[4:7], s53 offen nt
    s_add_u32 s53, s53, s54
    s_waitcnt vmcnt(5)
    v_mfma_f32_16x16x32_bf16 v[12:15], v[112:115], v[72:75], v[12:15]
    s_bitcmp1_b32 s16, 16
    s_cbranch_scc1 L_PACE80
    s_waitcnt vmcnt(4)
L_PACE80:
    buffer_load_dwordx4 v[104:107], v1, s[4:7], s53 offen nt
    s_add_u32 s53, s53, s54
    s_waitcnt vmcnt(5)
    v_mfma_f32_16x16x32_bf16 v[12:15], v[116:119], v[76:79], v[12:15]
    s_bitcmp1_b32 s16, 17
    s_cbranch_scc1 L_PACE81
    s_waitcnt vmcnt(4)
L_PACE81:
    buffer_load_dwordx4 v[108:111], v1, s[4:7], s53 offen nt
    s_add_u32 s53, s53, s54
    s_waitcnt vmcnt(5)
    v_mfma_f32_16x16x32_bf16 v[16:19], v[120:123], v[64:67], 0
    s_bitcmp1_b32 s16, 18
    s_cbranch_scc1 L_PACE82
    s_waitcnt vmcnt(4)
L_PACE82:
    buffer_load_dwordx4 v[112:115], v1, s[4:7], s53 offen nt
    s_add_u32 s53, s53, s54
    s_waitcnt vmcnt(5)
    v_mfma_f32_16x16x32_bf16 v[16:19], v[124:127], v[68:71], v[16:19]
    v_mov_b32_dpp v38, v12 quad_perm:[0,0,0,0] row_mask:0xf bank_mask:0xf
    v_mov_b32_dpp v52, v14 quad_perm:[2,2,2,2] row_mask:0xf bank_mask:0xf
    s_nop 0
    v_add_f32_dpp v38, v13, v38 quad_perm:[1,1,1,1] row_mask:0xf bank_mask:0xf
    v_add_f32_dpp v52, v15, v52 quad_perm:[3,3,3,3] row_mask:0xf bank_mask:0xf
    v_add_f32 v38, v38, v52
    s_bitcmp1_b32 s16, 19
    s_cbranch_scc1 L_PACE83
    s_waitcnt vmcnt(4)
L_PACE83:
    buffer_load_dwordx4 v[116:119], v1, s[4:7], s53 offen nt
    s_add_u32 s53, s53, s54
    s_waitcnt vmcnt(5)
    v_mfma_f32_16x16x32_bf16 v[16:19], v[96:99], v[72:75], v[16:19]
    s_bitcmp1_b32 s16, 20
    s_cbranch_scc1 L_PACE84
    s_waitcnt vmcnt(4)
L_PACE84:
    buffer_load_dwordx4 v[120:123], v1, s[4:7], s53 offen nt
    s_add_u32 s53, s53, s54
    s_waitcnt vmcnt(5)
    v_mfma_f32_16x16x32_bf16 v[16:19], v[100:103], v[76:79], v[16:19]
    s_bitcmp1_b32 s16, 21
    s_cbranch_scc1 L_PACE85
    s_waitcnt vmcnt(4)
L_PACE85:
    buffer_load_dwordx4 v[124:127], v1, s[4:7], s53 offen nt
    s_add_u32 s53, s53, s54
    s_waitcnt vmcnt(5)
    v_mfma_f32_16x16x32_bf16 v[12:15], v[104:107], v[64:67], 0
    s_bitcmp1_b32 s16, 22
    s_cbranch_scc1 L_PACE86
    s_waitcnt vmcnt(4)
L_PACE86:
    buffer_load_dwordx4 v[96:99], v1, s[4:7], s53 offen nt
    s_add_u32 s53, s53, s54
    s_waitcnt vmcnt(5)
    v_mfma_f32_16x16x32_bf16 v[12:15], v[108:111], v[68:71], v[12:15]
    v_mov_b32_dpp v39, v16 quad_perm:[0,0,0,0] row_mask:0xf bank_mask:0xf
    v_mov_b32_dpp v52, v18 quad_perm:[2,2,2,2] row_mask:0xf bank_mask:0xf
    s_nop 0
    v_add_f32_dpp v39, v17, v39 quad_perm:[1,1,1,1] row_mask:0xf bank_mask:0xf
    v_add_f32_dpp v52, v19, v52 quad_perm:[3,3,3,3] row_mask:0xf bank_mask:0xf
    v_add_f32 v39, v39, v52
    s_bitcmp1_b32 s16, 23
    s_cbranch_scc1 L_PACE87
    s_waitcnt vmcnt(4)
L_PACE87:
    buffer_load_dwordx4 v[100:103], v1, s[4:7], s53 offen nt
    s_add_u32 s53, s53, s54
    s_waitcnt vmcnt(5)
    v_mfma_f32_16x16x32_bf16 v[12:15], v[112:115], v[72:75], v[12:15]
    s_bitcmp1_b32 s16, 24
    s_cbranch_scc1 L_PACE88
    s_waitcnt vmcnt(4)
L_PACE88:
    buffer_load_dwordx4 v[104:107], v1, s[4:7], s53 offen nt
    s_add_u32 s53, s53, s54
    s_waitcnt vmcnt(5)
    v_mfma_f32_16x16x32_bf16 v[12:15], v[116:119], v[76:79], v[12:15]
    s_bitcmp1_b32 s16, 25
    s_cbranch_scc1 L_PACE89
    s_waitcnt vmcnt(4)
L_PACE89:
    buffer_load_dwordx4 v[108:111], v1, s[4:7], s53 offen nt
    s_add_u32 s53, s53, s54
    s_waitcnt vmcnt(5)
    v_mfma_f32_16x16x32_bf16 v[16:19], v[120:123], v[64:67], 0
    s_bitcmp1_b32 s16, 26
    s_cbranch_scc1 L_PACE90
    s_waitcnt vmcnt(4)
L_PACE90:
    buffer_load_dwordx4 v[112:115], v1, s[4:7], s53 offen nt
    s_add_u32 s53, s53, s54
    s_waitcnt vmcnt(5)
    v_mfma_f32_16x16x32_bf16 v[16:19], v[124:127], v[68:71], v[16:19]
    v_mov_b32_dpp v40, v12 quad_perm:[0,0,0,0] row_mask:0xf bank_mask:0xf
    v_mov_b32_dpp v52, v14 quad_perm:[2,2,2,2] row_mask:0xf bank_mask:0xf
    s_nop 0
    v_add_f32_dpp v40, v13, v40 quad_perm:[1,1,1,1] row_mask:0xf bank_mask:0xf
    v_add_f32_dpp v52, v15, v52 quad_perm:[3,3,3,3] row_mask:0xf bank_mask:0xf
    v_add_f32 v40, v40, v52
    s_bitcmp1_b32 s16, 27
    s_cbranch_scc1 L_PACE91
    s_waitcnt vmcnt(4)
L_PACE91:
    buffer_load_dwordx4 v[116:119], v1, s[4:7], s53 offen nt
    s_add_u32 s53, s53, s54
    s_waitcnt vmcnt(5)
    v_mfma_f32_16x16x32_bf16 v[16:19], v[96:99], v[72:75], v[16:19]
    s_bitcmp1_b32 s16, 28
    s_cbranch_scc1 L_PACE92
    s_waitcnt vmcnt(4)
L_PACE92:
    buffer_load_dwordx4 v[120:123], v1, s[4:7], s53 offen nt
    s_add_u32 s53, s53, s54
    s_waitcnt vmcnt(5)
    v_mfma_f32_16x16x32_bf16 v[16:19], v[100:103], v[76:79], v[16:19]
    s_bitcmp1_b32 s16, 29
    s_cbranch_scc1 L_PACE93
    s_waitcnt vmcnt(4)
L_PACE93:
    buffer_load_dwordx4 v[124:127], v1, s[4:7], s53 offen nt
    s_add_u32 s53, s53, s54
    s_waitcnt vmcnt(5)
    v_mfma_f32_16x16x32_bf16 v[12:15], v[104:107], v[64:67], 0
    s_bitcmp1_b32 s16, 30
    s_cbranch_scc1 L_PACE94
    s_waitcnt vmcnt(4)
L_PACE94:
    buffer_load_dwordx4 v[96:99], v1, s[4:7], s53 offen nt
    s_add_u32 s53, s53, s54
    s_waitcnt vmcnt(5)
    v_mfma_f32_16x16x32_bf16 v[12:15], v[108:111], v[68:71], v[12:15]
    v_mov_b32_dpp v41, v16 quad_perm:[0,0,0,0] row_mask:0xf bank_mask:0xf
    v_mov_b32_dpp v52, v18 quad_perm:[2,2,2,2] row_mask:0xf bank_mask:0xf
    s_nop 0
    v_add_f32_dpp v41, v17, v41 quad_perm:[1,1,1,1] row_mask:0xf bank_mask:0xf
    v_add_f32_dpp v52, v19, v52 quad_perm:[3,3,3,3] row_mask:0xf bank_mask:0xf
    v_add_f32 v41, v41, v52
    s_bitcmp1_b32 s16, 31
    s_cbranch_scc1 L_PACE95
    s_waitcnt vmcnt(4)
L_PACE95:
    buffer_load_dwordx4 v[100:103], v1, s[4:7], s53 offen nt
    s_add_u32 s53, s53, s54
    s_waitcnt vmcnt(5)
    v_mfma_f32_16x16x32_bf16 v[12:15], v[112:115], v[72:75], v[12:15]
    s_bitcmp1_b32 s16, 0
    s_cbranch_scc1 L_PACE96
    s_waitcnt vmcnt(4)
L_PACE96:
    buffer_load_dwordx4 v[104:107], v1, s[4:7], s53 offen nt
    s_add_u32 s53, s53, s54
    s_waitcnt vmcnt(5)
    v_mfma_f32_16x16x32_bf16 v[12:15], v[116:119], v[76:79], v[12:15]
    s_bitcmp1_b32 s16, 1
    s_cbranch_scc1 L_PACE97
    s_waitcnt vmcnt(4)
L_PACE97:
    buffer_load_dwordx4 v[108:111], v1, s[4:7], s53 offen nt
    s_add_u32 s53, s53, s54
    s_waitcnt vmcnt(5)
    v_mfma_f32_16x16x32_bf16 v[16:19], v[120:123], v[64:67], 0
    s_bitcmp1_b32 s16, 2
    s_cbranch_scc1 L_PACE98
    s_waitcnt vmcnt(4)
L_PACE98:
    buffer_load_dwordx4 v[112:115], v1, s[4:7], s53 offen nt
    s_add_u32 s53, s53, s54
    s_waitcnt vmcnt(5)
    v_mfma_f32_16x16x32_bf16 v[16:19], v[124:127], v[68:71], v[16:19]
    v_mov_b32_dpp v42, v12 quad_perm:[0,0,0,0] row_mask:0xf bank_mask:0xf
    v_mov_b32_dpp v52, v14 quad_perm:[2,2,2,2] row_mask:0xf bank_mask:0xf
    s_nop 0
    v_add_f32_dpp v42, v13, v42 quad_perm:[1,1,1,1] row_mask:0xf bank_mask:0xf
    v_add_f32_dpp v52, v15, v52 quad_perm:[3,3,3,3] row_mask:0xf bank_mask:0xf
    v_add_f32 v42, v42, v52
    s_bitcmp1_b32 s16, 3
    s_cbranch_scc1 L_PACE99
    s_waitcnt vmcnt(4)
L_PACE99:
    buffer_load_dwordx4 v[116:119], v1, s[4:7], s53 offen nt
    s_add_u32 s53, s53, s54
    s_waitcnt vmcnt(5)
    v_mfma_f32_16x16x32_bf16 v[16:19], v[96:99], v[72:75], v[16:19]
    s_bitcmp1_b32 s16, 4
    s_cbranch_scc1 L_PACE100
    s_waitcnt vmcnt(4)
L_PACE100:
    buffer_load_dwordx4 v[120:123], v1, s[4:7], s53 offen nt
    s_add_u32 s53, s53, s54
    s_waitcnt vmcnt(5)
    v_mfma_f32_16x16x32_bf16 v[16:19], v[100:103], v[76:79], v[16:19]
    s_bitcmp1_b32 s16, 5
    s_cbranch_scc1 L_PACE101
    s_waitcnt vmcnt(4)
L_PACE101:
    buffer_load_dwordx4 v[124:127], v1, s[4:7], s53 offen nt
    s_add_u32 s53, s53, s54
    s_waitcnt vmcnt(5)
    v_mfma_f32_16x16x32_bf16 v[12:15], v[104:107], v[64:67], 0
    s_bitcmp1_b32 s16, 6
    s_cbranch_scc1 L_PACE102
    s_waitcnt vmcnt(4)
L_PACE102:
    buffer_load_dwordx4 v[96:99], v1, s[4:7], s53 offen nt
    s_add_u32 s53, s53, s54
    s_waitcnt vmcnt(5)
    v_mfma_f32_16x16x32_bf16 v[12:15], v[108:111], v[68:71], v[12:15]
    v_mov_b32_dpp v43, v16 quad_perm:[0,0,0,0] row_mask:0xf bank_mask:0xf
    v_mov_b32_dpp v52, v18 quad_perm:[2,2,2,2] row_mask:0xf bank_mask:0xf
    s_nop 0
    v_add_f32_dpp v43, v17, v43 quad_perm:[1,1,1,1] row_mask:0xf bank_mask:0xf
    v_add_f32_dpp v52, v19, v52 quad_perm:[3,3,3,3] row_mask:0xf bank_mask:0xf
    v_add_f32 v43, v43, v52
    s_bitcmp1_b32 s16, 7
    s_cbranch_scc1 L_PACE103
    s_waitcnt vmcnt(4)
L_PACE103:
    buffer_load_dwordx4 v[100:103], v1, s[4:7], s53 offen nt
    s_add_u32 s53, s53, s54
    s_waitcnt vmcnt(5)
    v_mfma_f32_16x16x32_bf16 v[12:15], v[112:115], v[72:75], v[12:15]
    s_bitcmp1_b32 s16, 8
    s_cbranch_scc1 L_PACE104
    s_waitcnt vmcnt(4)
L_PACE104:
    buffer_load_dwordx4 v[104:107], v1, s[4:7], s53 offen nt
    s_add_u32 s53, s53, s54
    s_waitcnt vmcnt(5)
    v_mfma_f32_16x16x32_bf16 v[12:15], v[116:119], v[76:79], v[12:15]
    s_bitcmp1_b32 s16, 9
    s_cbranch_scc1 L_PACE105
    s_waitcnt vmcnt(4)
L_PACE105:
    buffer_load_dwordx4 v[108:111], v1, s[4:7], s53 offen nt
    s_add_u32 s53, s53, s54
    s_waitcnt vmcnt(5)
    v_mfma_f32_16x16x32_bf16 v[16:19], v[120:123], v[64:67], 0
    s_bitcmp1_b32 s16, 10
    s_cbranch_scc1 L_PACE106
    s_waitcnt vmcnt(4)
L_PACE106:
    buffer_load_dwordx4 v[112:115], v1, s[4:7], s53 offen nt
    s_add_u32 s53, s53, s54
    s_waitcnt vmcnt(5)
    v_mfma_f32_16x16x32_bf16 v[16:19], v[124:127], v[68:71], v[16:19]
    v_mov_b32_dpp v44, v12 quad_perm:[0,0,0,0] row_mask:0xf bank_mask:0xf
    v_mov_b32_dpp v52, v14 quad_perm:[2,2,2,2] row_mask:0xf bank_mask:0xf
    s_nop 0
    v_add_f32_dpp v44, v13, v44 quad_perm:[1,1,1,1] row_mask:0xf bank_mask:0xf
    v_add_f32_dpp v52, v15, v52 quad_perm:[3,3,3,3] row_mask:0xf bank_mask:0xf
    v_add_f32 v44, v44, v52
    s_bitcmp1_b32 s16, 11
    s_cbranch_scc1 L_PACE107
    s_waitcnt vmcnt(4)
L_PACE107:
    buffer_load_dwordx4 v[116:119], v1, s[4:7], s53 offen nt
    s_add_u32 s53, s53, s54
    s_waitcnt vmcnt(5)
    v_mfma_f32_16x16x32_bf16 v[16:19], v[96:99], v[72:75], v[16:19]
    s_bitcmp1_b32 s16, 12
    s_cbranch_scc1 L_PACE108
    s_waitcnt vmcnt(4)
L_PACE108:
    buffer_load_dwordx4 v[120:123], v1, s[4:7], s53 offen nt
    s_add_u32 s53, s53, s54
    s_waitcnt vmcnt(5)
    v_mfma_f32_16x16x32_bf16 v[16:19], v[100:103], v[76:79], v[16:19]
    s_bitcmp1_b32 s16, 13
    s_cbranch_scc1 L_PACE109
    s_waitcnt vmcnt(4)
L_PACE109:
    buffer_load_dwordx4 v[124:127], v1, s[4:7], s53 offen nt
    s_add_u32 s53, s53, s54
    s_waitcnt vmcnt(5)
    v_mfma_f32_16x16x32_bf16 v[12:15], v[104:107], v[64:67], 0
    s_bitcmp1_b32 s16, 14
    s_cbranch_scc1 L_PACE110
    s_waitcnt vmcnt(4)
L_PACE110:
    buffer_load_dwordx4 v[96:99], v1, s[4:7], s53 offen nt
    s_add_u32 s53, s53, s54
    s_waitcnt vmcnt(5)
    v_mfma_f32_16x16x32_bf16 v[12:15], v[108:111], v[68:71], v[12:15]
    v_mov_b32_dpp v45, v16 quad_perm:[0,0,0,0] row_mask:0xf bank_mask:0xf
    v_mov_b32_dpp v52, v18 quad_perm:[2,2,2,2] row_mask:0xf bank_mask:0xf
    s_nop 0
    v_add_f32_dpp v45, v17, v45 quad_perm:[1,1,1,1] row_mask:0xf bank_mask:0xf
    v_add_f32_dpp v52, v19, v52 quad_perm:[3,3,3,3] row_mask:0xf bank_mask:0xf
    v_add_f32 v45, v45, v52
    s_bitcmp1_b32 s16, 15
    s_cbranch_scc1 L_PACE111
    s_waitcnt vmcnt(4)
L_PACE111:
    buffer_load_dwordx4 v[100:103], v1, s[4:7], s53 offen nt
    s_add_u32 s53, s53, s54
    s_waitcnt vmcnt(5)
    v_mfma_f32_16x16x32_bf16 v[12:15], v[112:115], v[72:75], v[12:15]
    s_bitcmp1_b32 s16, 16
    s_cbranch_scc1 L_PACE112
    s_waitcnt vmcnt(4)
L_PACE112:
    buffer_load_dwordx4 v[104:107], v1, s[4:7], s53 offen nt
    s_add_u32 s53, s53, s54
    s_waitcnt vmcnt(5)
    v_mfma_f32_16x16x32_bf16 v[12:15], v[116:119], v[76:79], v[12:15]
    s_bitcmp1_b32 s16, 17
    s_cbranch_scc1 L_PACE113
    s_waitcnt vmcnt(4)
L_PACE113:
    buffer_load_dwordx4 v[108:111], v1, s[4:7], s53 offen nt
    s_add_u32 s53, s53, s54
    s_waitcnt vmcnt(5)
    v_mfma_f32_16x16x32_bf16 v[16:19], v[120:123], v[64:67], 0
    s_bitcmp1_b32 s16, 18
    s_cbranch_scc1 L_PACE114
    s_waitcnt vmcnt(4)
L_PACE114:
    buffer_load_dwordx4 v[112:115], v1, s[4:7], s53 offen nt
    s_add_u32 s53, s53, s54
    s_waitcnt vmcnt(5)
    v_mfma_f32_16x16x32_bf16 v[16:19], v[124:127], v[68:71], v[16:19]
    v_mov_b32_dpp v46, v12 quad_perm:[0,0,0,0] row_mask:0xf bank_mask:0xf
    v_mov_b32_dpp v52, v14 quad_perm:[2,2,2,2] row_mask:0xf bank_mask:0xf
    s_nop 0
    v_add_f32_dpp v46, v13, v46 quad_perm:[1,1,1,1] row_mask:0xf bank_mask:0xf
    v_add_f32_dpp v52, v15, v52 quad_perm:[3,3,3,3] row_mask:0xf bank_mask:0xf
    v_add_f32 v46, v46, v52
    s_bitcmp1_b32 s16, 19
    s_cbranch_scc1 L_PACE115
    s_waitcnt vmcnt(4)
L_PACE115:
    buffer_load_dwordx4 v[116:119], v1, s[4:7], s53 offen nt
    s_add_u32 s53, s53, s54
    s_waitcnt vmcnt(5)
    v_mfma_f32_16x16x32_bf16 v[16:19], v[96:99], v[72:75], v[16:19]
    s_bitcmp1_b32 s16, 20
    s_cbranch_scc1 L_PACE116
    s_waitcnt vmcnt(4)
L_PACE116:
    buffer_load_dwordx4 v[120:123], v1, s[4:7], s53 offen nt
    s_add_u32 s53, s53, s54
    s_waitcnt vmcnt(5)
    v_mfma_f32_16x16x32_bf16 v[16:19], v[100:103], v[76:79], v[16:19]
    s_bitcmp1_b32 s16, 21
    s_cbranch_scc1 L_PACE117
    s_waitcnt vmcnt(4)
L_PACE117:
    buffer_load_dwordx4 v[124:127], v1, s[4:7], s53 offen nt
    s_add_u32 s53, s53, s54
    s_waitcnt vmcnt(5)
    v_mfma_f32_16x16x32_bf16 v[12:15], v[104:107], v[64:67], 0
    s_bitcmp1_b32 s16, 22
    s_cbranch_scc1 L_PACE118
    s_waitcnt vmcnt(4)
L_PACE118:
    buffer_load_dwordx4 v[96:99], v1, s[4:7], s53 offen nt
    s_add_u32 s53, s53, s54
    s_waitcnt vmcnt(5)
    v_mfma_f32_16x16x32_bf16 v[12:15], v[108:111], v[68:71], v[12:15]
    v_mov_b32_dpp v47, v16 quad_perm:[0,0,0,0] row_mask:0xf bank_mask:0xf
    v_mov_b32_dpp v52, v18 quad_perm:[2,2,2,2] row_mask:0xf bank_mask:0xf
    s_nop 0
    v_add_f32_dpp v47, v17, v47 quad_perm:[1,1,1,1] row_mask:0xf bank_mask:0xf
    v_add_f32_dpp v52, v19, v52 quad_perm:[3,3,3,3] row_mask:0xf bank_mask:0xf
    v_add_f32 v47, v47, v52
    s_bitcmp1_b32 s16, 23
    s_cbranch_scc1 L_PACE119
    s_waitcnt vmcnt(4)
L_PACE119:
    buffer_load_dwordx4 v[100:103], v1, s[4:7], s53 offen nt
    s_add_u32 s53, s53, s54
    s_waitcnt vmcnt(5)
    v_mfma_f32_16x16x32_bf16 v[12:15], v[112:115], v[72:75], v[12:15]
    s_bitcmp1_b32 s16, 24
    s_cbranch_scc1 L_PACE120
    s_waitcnt vmcnt(4)
L_PACE120:
    buffer_load_dwordx4 v[104:107], v1, s[4:7], s53 offen nt
    s_add_u32 s53, s53, s54
    s_waitcnt vmcnt(5)
    v_mfma_f32_16x16x32_bf16 v[12:15], v[116:119], v[76:79], v[12:15]
    s_bitcmp1_b32 s16, 25
    s_cbranch_scc1 L_PACE121
    s_waitcnt vmcnt(4)
L_PACE121:
    buffer_load_dwordx4 v[108:111], v1, s[4:7], s53 offen nt
    s_add_u32 s53, s53, s54
    s_waitcnt vmcnt(5)
    v_mfma_f32_16x16x32_bf16 v[16:19], v[120:123], v[64:67], 0
    s_bitcmp1_b32 s16, 26
    s_cbranch_scc1 L_PACE122
    s_waitcnt vmcnt(4)
L_PACE122:
    buffer_load_dwordx4 v[112:115], v1, s[4:7], s53 offen nt
    s_add_u32 s53, s53, s54
    s_waitcnt vmcnt(5)
    v_mfma_f32_16x16x32_bf16 v[16:19], v[124:127], v[68:71], v[16:19]
    v_mov_b32_dpp v48, v12 quad_perm:[0,0,0,0] row_mask:0xf bank_mask:0xf
    v_mov_b32_dpp v52, v14 quad_perm:[2,2,2,2] row_mask:0xf bank_mask:0xf
    s_nop 0
    v_add_f32_dpp v48, v13, v48 quad_perm:[1,1,1,1] row_mask:0xf bank_mask:0xf
    v_add_f32_dpp v52, v15, v52 quad_perm:[3,3,3,3] row_mask:0xf bank_mask:0xf
    v_add_f32 v48, v48, v52
    s_bitcmp1_b32 s16, 27
    s_cbranch_scc1 L_PACE123
    s_waitcnt vmcnt(4)
L_PACE123:
    buffer_load_dwordx4 v[116:119], v1, s[4:7], s53 offen nt
    s_add_u32 s53, s53, s54
    s_waitcnt vmcnt(5)
    v_mfma_f32_16x16x32_bf16 v[16:19], v[96:99], v[72:75], v[16:19]
    s_bitcmp1_b32 s16, 28
    s_cbranch_scc1 L_PACE124
    s_waitcnt vmcnt(4)
L_PACE124:
    buffer_load_dwordx4 v[120:123], v1, s[4:7], s53 offen nt
    s_add_u32 s53, s53, s54
    s_waitcnt vmcnt(5)
    v_mfma_f32_16x16x32_bf16 v[16:19], v[100:103], v[76:79], v[16:19]
    s_bitcmp1_b32 s16, 29
    s_cbranch_scc1 L_PACE125
    s_waitcnt vmcnt(4)
L_PACE125:
    buffer_load_dwordx4 v[124:127], v1, s[4:7], s53 offen nt
    s_add_u32 s53, s53, s54
    s_waitcnt vmcnt(5)
    v_mfma_f32_16x16x32_bf16 v[12:15], v[104:107], v[64:67], 0
    s_bitcmp1_b32 s16, 30
    s_cbranch_scc1 L_PACE126
    s_waitcnt vmcnt(4)
L_PACE126:
    buffer_load_dwordx4 v[96:99], v1, s[4:7], s53 offen nt
    s_add_u32 s53, s53, s54
    s_waitcnt vmcnt(5)
    v_mfma_f32_16x16x32_bf16 v[12:15], v[108:111], v[68:71], v[12:15]
    v_mov_b32_dpp v49, v16 quad_perm:[0,0,0,0] row_mask:0xf bank_mask:0xf
    v_mov_b32_dpp v52, v18 quad_perm:[2,2,2,2] row_mask:0xf bank_mask:0xf
    s_nop 0
    v_add_f32_dpp v49, v17, v49 quad_perm:[1,1,1,1] row_mask:0xf bank_mask:0xf
    v_add_f32_dpp v52, v19, v52 quad_perm:[3,3,3,3] row_mask:0xf bank_mask:0xf
    v_add_f32 v49, v49, v52
    s_bitcmp1_b32 s16, 31
    s_cbranch_scc1 L_PACE127
    s_waitcnt vmcnt(4)
L_PACE127:
    buffer_load_dwordx4 v[100:103], v1, s[4:7], s53 offen nt
    s_waitcnt vmcnt(5)
    v_mfma_f32_16x16x32_bf16 v[12:15], v[112:115], v[72:75], v[12:15]
    s_bitcmp1_b32 s17, 0
    s_cbranch_scc1 L_PACE128
    s_waitcnt vmcnt(4)
L_PACE128:
    s_mov_b32 s53, s52
    buffer_load_dwordx4 v[104:107], v2, s[8:11], s53 offen nt
    s_add_u32 s53, s53, s54
    s_waitcnt vmcnt(5)
    v_mfma_f32_16x16x32_bf16 v[12:15], v[116:119], v[76:79], v[12:15]
    s_bitcmp1_b32 s17, 1
    s_cbranch_scc1 L_PACE129
    s_waitcnt vmcnt(4)
L_PACE129:
    buffer_load_dwordx4 v[108:111], v2, s[8:11], s53 offen nt
    s_add_u32 s53, s53, s54
    s_waitcnt vmcnt(5)
    v_mfma_f32_16x16x32_bf16 v[16:19], v[120:123], v[64:67], 0
    s_bitcmp1_b32 s17, 2
    s_cbranch_scc1 L_PACE130
    s_waitcnt vmcnt(4)
L_PACE130:
    buffer_load_dwordx4 v[112:115], v2, s[8:11], s53 offen nt
    s_add_u32 s53, s53, s54
    s_waitcnt vmcnt(5)
    v_mfma_f32_16x16x32_bf16 v[16:19], v[124:127], v[68:71], v[16:19]
    v_mov_b32_dpp v50, v12 quad_perm:[0,0,0,0] row_mask:0xf bank_mask:0xf
    v_mov_b32_dpp v52, v14 quad_perm:[2,2,2,2] row_mask:0xf bank_mask:0xf
    s_nop 0
    v_add_f32_dpp v50, v13, v50 quad_perm:[1,1,1,1] row_mask:0xf bank_mask:0xf
    v_add_f32_dpp v52, v15, v52 quad_perm:[3,3,3,3] row_mask:0xf bank_mask:0xf
    v_add_f32 v50, v50, v52
    s_bitcmp1_b32 s17, 3
    s_cbranch_scc1 L_PACE131
    s_waitcnt vmcnt(4)
L_PACE131:
    buffer_load_dwordx4 v[116:119], v2, s[8:11], s53 offen nt
    s_add_u32 s53, s53, s54
    s_waitcnt vmcnt(5)
    v_mfma_f32_16x16x32_bf16 v[16:19], v[96:99], v[72:75], v[16:19]
    s_bitcmp1_b32 s17, 4
    s_cbranch_scc1 L_PACE132
    s_waitcnt vmcnt(4)
L_PACE132:
    buffer_load_dwordx4 v[120:123], v2, s[8:11], s53 offen nt
    s_add_u32 s53, s53, s54
    s_waitcnt vmcnt(5)
    v_mfma_f32_16x16x32_bf16 v[16:19], v[100:103], v[76:79], v[16:19]
    s_nop 7
    v_mov_b32_dpp v51, v16 quad_perm:[0,0,0,0] row_mask:0xf bank_mask:0xf
    v_mov_b32_dpp v52, v18 quad_perm:[2,2,2,2] row_mask:0xf bank_mask:0xf
    s_nop 0
    v_add_f32_dpp v51, v17, v51 quad_perm:[1,1,1,1] row_mask:0xf bank_mask:0xf
    v_add_f32_dpp v52, v19, v52 quad_perm:[3,3,3,3] row_mask:0xf bank_mask:0xf
    v_add_f32 v51, v51, v52
    v_max3_f32 v52, v20, v21, v22
    v_max3_f32 v52, v52, v23, v24
    v_max3_f32 v52, v52, v25, v26
    v_max3_f32 v52, v52, v27, v28
    v_max3_f32 v52, v52, v29, v30
    v_max3_f32 v52, v52, v31, v32
    v_max3_f32 v52, v52, v33, v34
    v_max3_f32 v52, v52, v35, v36
    v_max3_f32 v52, v52, v37, v38
    v_max3_f32 v52, v52, v39, v40
    v_max3_f32 v52, v52, v41, v42
    v_max3_f32 v52, v52, v43, v44
    v_max3_f32 v52, v52, v45, v46
    v_max3_f32 v52, v52, v47, v48
    v_max3_f32 v52, v52, v49, v50
    v_max_f32 v52, v52, v51
    s_nop 1
    v_max_f32_dpp v52, v52, v52 row_ror:4 row_mask:0xf bank_mask:0xf
    s_nop 1
    v_max_f32_dpp v52, v52, v52 row_ror:8 row_mask:0xf bank_mask:0xf
    v_mov_b32 v53, v52
    s_nop 1
    v_permlane16_swap_b32 v52, v53
    v_max_f32 v52, v52, v53
    v_mov_b32 v53, v52
    s_nop 1
    v_permlane32_swap_b32 v52, v53
    v_max_f32 v52, v52, v53
    v_mul_f32 v54, s55, v52
    s_bitcmp1_b32 s17, 5
    s_cbranch_scc1 L_PACE133
    s_waitcnt vmcnt(4)
L_PACE133:
    buffer_load_dwordx4 v[124:127], v2, s[8:11], s53 offen nt
    s_add_u32 s53, s53, s54
    v_fma_f32 v20, v20, s55, -v54
    v_fma_f32 v21, v21, s55, -v54
    v_fma_f32 v22, v22, s55, -v54
    v_fma_f32 v23, v23, s55, -v54
    v_fma_f32 v24, v24, s55, -v54
    v_fma_f32 v25, v25, s55, -v54
    v_fma_f32 v26, v26, s55, -v54
    v_fma_f32 v27, v27, s55, -v54
    v_fma_f32 v28, v28, s55, -v54
    v_fma_f32 v29, v29, s55, -v54
    v_fma_f32 v30, v30, s55, -v54
    v_fma_f32 v31, v31, s55, -v54
    v_fma_f32 v32, v32, s55, -v54
    v_fma_f32 v33, v33, s55, -v54
    v_fma_f32 v34, v34, s55, -v54
    v_fma_f32 v35, v35, s55, -v54
    v_fma_f32 v36, v36, s55, -v54
    v_fma_f32 v37, v37, s55, -v54
    v_fma_f32 v38, v38, s55, -v54
    v_fma_f32 v39, v39, s55, -v54
    v_fma_f32 v40, v40, s55, -v54
    v_fma_f32 v41, v41, s55, -v54
    v_fma_f32 v42, v42, s55, -v54
    v_fma_f32 v43, v43, s55, -v54
    v_fma_f32 v44, v44, s55, -v54
    v_fma_f32 v45, v45, s55, -v54
    v_fma_f32 v46, v46, s55, -v54
    v_fma_f32 v47, v47, s55, -v54
    v_fma_f32 v48, v48, s55, -v54
    v_fma_f32 v49, v49, s55, -v54
    v_fma_f32 v50, v50, s55, -v54
    v_fma_f32 v51, v51, s55, -v54
    v_exp_f32 v20, v20
    v_exp_f32 v21, v21
    v_exp_f32 v22, v22
    v_exp_f32 v23, v23
    v_exp_f32 v24, v24
    v_exp_f32 v25, v25
    v_exp_f32 v26, v26
    v_exp_f32 v27, v27
    v_exp_f32 v28, v28
    v_exp_f32 v29, v29
    v_exp_f32 v30, v30
    v_exp_f32 v31, v31
    v_exp_f32 v32, v32
    v_exp_f32 v33, v33
    v_exp_f32 v34, v34
    v_exp_f32 v35, v35
    s_waitcnt vmcnt(5)
    s_bitcmp1_b32 s17, 6
    s_cbranch_scc1 L_PACE134
    s_waitcnt vmcnt(4)
L_PACE134:
    buffer_load_dwordx4 v[96:99], v2, s[8:11], s53 offen nt
    s_add_u32 s53, s53, s54
    v_exp_f32 v36, v36
    v_exp_f32 v37, v37
    v_exp_f32 v38, v38
    v_exp_f32 v39, v39
    v_exp_f32 v40, v40
    v_exp_f32 v41, v41
    v_exp_f32 v42, v42
    v_exp_f32 v43, v43
    v_exp_f32 v44, v44
    v_exp_f32 v45, v45
    v_exp_f32 v46, v46
    v_exp_f32 v47, v47
    v_exp_f32 v48, v48
    v_exp_f32 v49, v49
    v_exp_f32 v50, v50
    v_exp_f32 v51, v51
    s_waitcnt vmcnt(5)
    s_bitcmp1_b32 s17, 7
    s_cbranch_scc1 L_PACE135
    s_waitcnt vmcnt(4)
L_PACE135:
    buffer_load_dwordx4 v[100:103], v2, s[8:11], s53 offen nt
    s_add_u32 s53, s53, s54
    v_add_f32 v52, v20, v21
    v_add_f32 v53, v22, v23
    v_add_f32 v52, v52, v24
    v_add_f32 v53, v53, v25
    v_add_f32 v52, v52, v26
    v_add_f32 v53, v53, v27
    v_add_f32 v52, v52, v28
    v_add_f32 v53, v53, v29
    v_add_f32 v52, v52, v30
    v_add_f32 v53, v53, v31
    v_add_f32 v52, v52, v32
    v_add_f32 v53, v53, v33
    v_add_f32 v52, v52, v34
    v_add_f32 v53, v53, v35
    v_add_f32 v52, v52, v36
    v_add_f32 v53, v53, v37
    v_add_f32 v52, v52, v38
    v_add_f32 v53, v53, v39
    v_add_f32 v52, v52, v40
    v_add_f32 v53, v53, v41
    v_add_f32 v52, v52, v42
    v_add_f32 v53, v53, v43
    v_add_f32 v52, v52, v44
    v_add_f32 v53, v53, v45
    v_add_f32 v52, v52, v46
    v_add_f32 v53, v53, v47
    v_add_f32 v52, v52, v48
    v_add_f32 v53, v53, v49
    v_add_f32 v52, v52, v50
    v_add_f32 v53, v53, v51
    v_add_f32 v52, v52, v53
    v_cvt_pk_bf16_f32 v20, v20, v20
    v_cvt_pk_bf16_f32 v21, v21, v21
    v_cvt_pk_bf16_f32 v22, v22, v22
    v_cvt_pk_bf16_f32 v23, v23, v23
    v_cvt_pk_bf16_f32 v24, v24, v24
    v_cvt_pk_bf16_f32 v25, v25, v25
    v_cvt_pk_bf16_f32 v26, v26, v26
    v_cvt_pk_bf16_f32 v27, v27, v27
    v_cvt_pk_bf16_f32 v28, v28, v28
    v_cvt_pk_bf16_f32 v29, v29, v29
    v_cvt_pk_bf16_f32 v30, v30, v30
    v_cvt_pk_bf16_f32 v31, v31, v31
    v_cvt_pk_bf16_f32 v32, v32, v32
    v_cvt_pk_bf16_f32 v33, v33, v33
    v_cvt_pk_bf16_f32 v34, v34, v34
    v_cvt_pk_bf16_f32 v35, v35, v35
    v_cvt_pk_bf16_f32 v36, v36, v36
    v_cvt_pk_bf16_f32 v37, v37, v37
    v_cvt_pk_bf16_f32 v38, v38, v38
    v_cvt_pk_bf16_f32 v39, v39, v39
    v_cvt_pk_bf16_f32 v40, v40, v40
    v_cvt_pk_bf16_f32 v41, v41, v41
    v_cvt_pk_bf16_f32 v42, v42, v42
    v_cvt_pk_bf16_f32 v43, v43, v43
    v_cvt_pk_bf16_f32 v44, v44, v44
    v_cvt_pk_bf16_f32 v45, v45, v45
    v_cvt_pk_bf16_f32 v46, v46, v46
    v_cvt_pk_bf16_f32 v47, v47, v47
    v_cvt_pk_bf16_f32 v48, v48, v48
    v_cvt_pk_bf16_f32 v49, v49, v49
    v_cvt_pk_bf16_f32 v50, v50, v50
    v_cvt_pk_bf16_f32 v51, v51, v51
    s_waitcnt vmcnt(5)
    s_bitcmp1_b32 s17, 8
    s_cbranch_scc1 L_PACE136
    s_waitcnt vmcnt(4)
L_PACE136:
    buffer_load_dwordx4 v[84:87], v2, s[8:11], s53 offen nt
    s_add_u32 s53, s53, s54
    v_add_f32_dpp v52, v52, v52 row_ror:4 row_mask:0xf bank_mask:0xf
    s_nop 1
    v_add_f32_dpp v52, v52, v52 row_ror:8 row_mask:0xf bank_mask:0xf
    v_mov_b32 v53, v52
    s_nop 1
    v_permlane16_swap_b32 v52, v53
    v_add_f32 v52, v52, v53
    v_mov_b32 v53, v52
    s_nop 1
    v_permlane32_swap_b32 v52, v53
    v_add_f32 v52, v52, v53
    v_mov_b32 v55, v52
    s_lshl_b32 s59, s3, 3
    v_mov_b32 v53, s59
    s_mov_b64 exec, 1
    ds_write_b64 v53, v[54:55] offset:288
    v_mov_b32 v52, 1
    v_mov_b32 v53, 0
    ds_add_u32 v53, v52 offset:272
    s_mov_b64 exec, -1
    v_and_b32_dpp v12, v20, v4 row_newbcast:0 row_mask:0xf bank_mask:0xf
    v_and_b32_dpp v13, v20, v5 row_newbcast:0 row_mask:0xf bank_mask:0xf
    v_and_b32_dpp v14, v20, v6 row_newbcast:0 row_mask:0xf bank_mask:0xf
    v_and_b32_dpp v15, v20, v7 row_newbcast:0 row_mask:0xf bank_mask:0xf
    s_nop 1
    v_mfma_f32_16x16x32_bf16 v[8:11], v[12:15], v[104:107], v[8:11]
    v_and_b32_dpp v16, v20, v4 row_newbcast:4 row_mask:0xf bank_mask:0xf
    v_and_b32_dpp v17, v20, v5 row_newbcast:4 row_mask:0xf bank_mask:0xf
    v_and_b32_dpp v18, v20, v6 row_newbcast:4 row_mask:0xf bank_mask:0xf
    v_and_b32_dpp v19, v20, v7 row_newbcast:4 row_mask:0xf bank_mask:0xf
    s_nop 1
    v_mfma_f32_16x16x32_bf16 v[8:11], v[16:19], v[108:111], v[8:11]
    v_and_b32_dpp v12, v20, v4 row_newbcast:8 row_mask:0xf bank_mask:0xf
    v_and_b32_dpp v13, v20, v5 row_newbcast:8 row_mask:0xf bank_mask:0xf
    v_and_b32_dpp v14, v20, v6 row_newbcast:8 row_mask:0xf bank_mask:0xf
    v_and_b32_dpp v15, v20, v7 row_newbcast:8 row_mask:0xf bank_mask:0xf
    s_nop 1
    v_mfma_f32_16x16x32_bf16 v[8:11], v[12:15], v[112:115], v[8:11]
    v_and_b32 v54, 15, v0
    v_lshrrev_b32 v55, 4, v0
    v_lshlrev_b32 v56, 4, v54
    v_lshl_add_u32 v56, v55, 3, v56
    s_lshl_b32 s78, s3, 8
    v_add_u32 v56, s78, v56
    v_and_b32 v57, 3, v0
    v_lshlrev_b32 v57, 8, v57
    v_lshl_add_u32 v57, v55, 4, v57
    v_lshrrev_b32 v59, 2, v54
    v_lshlrev_b32 v58, 13, v59
    v_and_b32 v59, 3, v54
    v_lshl_add_u32 v58, v59, 5, v58
    v_and_b32 v59, 1, v55
    v_lshl_add_u32 v58, v59, 4, v58
    v_lshlrev_b32 v61, 5, v54
    v_lshl_add_u32 v61, v59, 4, v61
    s_lshl_b32 s78, s3, 9
    v_add_u32 v61, s78, v61
    s_lshl_b32 s76, s46, 4
    s_lshl_b32 s78, s3, 2
    s_add_u32 s76, s76, s78
    s_lshl_b32 s76, s76, 13
    s_lshl_b32 s78, s77, 7
    s_add_u32 s76, s76, s78
    s_add_u32 s76, s76, 0x100000
    v_mov_b32 v62, 0x3ff
    s_mov_b32 s72, 0xffff0000
    s_mov_b32 s73, 0xffff0000
    v_mov_b32 v60, 0
    s_waitcnt vmcnt(5)
    s_bitcmp1_b32 s17, 9
    s_cbranch_scc1 L_PACE137
    s_waitcnt vmcnt(4)
L_PACE137:
    buffer_load_dwordx4 v[104:107], v2, s[8:11], s53 offen nt
    s_add_u32 s53, s53, s54
    v_and_b32_dpp v16, v20, v4 row_newbcast:12 row_mask:0xf bank_mask:0xf
    v_and_b32_dpp v17, v20, v5 row_newbcast:12 row_mask:0xf bank_mask:0xf
    v_and_b32_dpp v18, v20, v6 row_newbcast:12 row_mask:0xf bank_mask:0xf
    v_and_b32_dpp v19, v20, v7 row_newbcast:12 row_mask:0xf bank_mask:0xf
    s_nop 1
    v_mfma_f32_16x16x32_bf16 v[8:11], v[16:19], v[116:119], v[8:11]
    v_and_b32_dpp v12, v21, v4 row_newbcast:0 row_mask:0xf bank_mask:0xf
    v_and_b32_dpp v13, v21, v5 row_newbcast:0 row_mask:0xf bank_mask:0xf
    v_and_b32_dpp v14, v21, v6 row_newbcast:0 row_mask:0xf bank_mask:0xf
    v_and_b32_dpp v15, v21, v7 row_newbcast:0 row_mask:0xf bank_mask:0xf
    s_waitcnt vmcnt(5)
    s_nop 0
    v_mfma_f32_16x16x32_bf16 v[8:11], v[12:15], v[120:123], v[8:11]
    s_bitcmp1_b32 s17, 10
    s_cbranch_scc1 L_PACE138
    s_waitcnt vmcnt(4)
L_PACE138:
    buffer_load_dwordx4 v[108:111], v2, s[8:11], s53 offen nt
    s_add_u32 s53, s53, s54
    v_and_b32_dpp v16, v21, v4 row_newbcast:4 row_mask:0xf bank_mask:0xf
    v_and_b32_dpp v17, v21, v5 row_newbcast:4 row_mask:0xf bank_mask:0xf
    v_and_b32_dpp v18, v21, v6 row_newbcast:4 row_mask:0xf bank_mask:0xf
    v_and_b32_dpp v19, v21, v7 row_newbcast:4 row_mask:0xf bank_mask:0xf
    s_waitcnt vmcnt(5)
    s_nop 0
    v_mfma_f32_16x16x32_bf16 v[8:11], v[16:19], v[124:127], v[8:11]
    s_bitcmp1_b32 s17, 11
    s_cbranch_scc1 L_PACE139
    s_waitcnt vmcnt(4)
L_PACE139:
    buffer_load_dwordx4 v[112:115], v2, s[8:11], s53 offen nt
    s_add_u32 s53, s53, s54
    v_and_b32_dpp v12, v21, v4 row_newbcast:8 row_mask:0xf bank_mask:0xf
    v_and_b32_dpp v13, v21, v5 row_newbcast:8 row_mask:0xf bank_mask:0xf
    v_and_b32_dpp v14, v21, v6 row_newbcast:8 row_mask:0xf bank_mask:0xf
    v_and_b32_dpp v15, v21, v7 row_newbcast:8 row_mask:0xf bank_mask:0xf
    s_waitcnt vmcnt(5)
    s_nop 0
    v_mfma_f32_16x16x32_bf16 v[8:11], v[12:15], v[96:99], v[8:11]
    s_bitcmp1_b32 s17, 12
    s_cbranch_scc1 L_PACE140
    s_waitcnt vmcnt(4)
L_PACE140:
    buffer_load_dwordx4 v[116:119], v2, s[8:11], s53 offen nt
    s_add_u32 s53, s53, s54
    v_and_b32_dpp v16, v21, v4 row_newbcast:12 row_mask:0xf bank_mask:0xf
    v_and_b32_dpp v17, v21, v5 row_newbcast:12 row_mask:0xf bank_mask:0xf
    v_and_b32_dpp v18, v21, v6 row_newbcast:12 row_mask:0xf bank_mask:0xf
    v_and_b32_dpp v19, v21, v7 row_newbcast:12 row_mask:0xf bank_mask:0xf
    s_waitcnt vmcnt(5)
    s_nop 0
    v_mfma_f32_16x16x32_bf16 v[8:11], v[16:19], v[100:103], v[8:11]
    s_bitcmp1_b32 s17, 13
    s_cbranch_scc1 L_PACE141
    s_waitcnt vmcnt(4)
L_PACE141:
    buffer_load_dwordx4 v[120:123], v2, s[8:11], s53 offen nt
    s_add_u32 s53, s53, s54
    v_and_b32_dpp v12, v22, v4 row_newbcast:0 row_mask:0xf bank_mask:0xf
    v_and_b32_dpp v13, v22, v5 row_newbcast:0 row_mask:0xf bank_mask:0xf
    v_and_b32_dpp v14, v22, v6 row_newbcast:0 row_mask:0xf bank_mask:0xf
    v_and_b32_dpp v15, v22, v7 row_newbcast:0 row_mask:0xf bank_mask:0xf
    s_waitcnt vmcnt(5)
    s_nop 0
    v_mfma_f32_16x16x32_bf16 v[8:11], v[12:15], v[84:87], v[8:11]
    s_bitcmp1_b32 s17, 14
    s_cbranch_scc1 L_PACE142
    s_waitcnt vmcnt(4)
L_PACE142:
    buffer_load_dwordx4 v[124:127], v2, s[8:11], s53 offen nt
    s_add_u32 s53, s53, s54
    v_and_b32_dpp v16, v22, v4 row_newbcast:4 row_mask:0xf bank_mask:0xf
    v_and_b32_dpp v17, v22, v5 row_newbcast:4 row_mask:0xf bank_mask:0xf
    v_and_b32_dpp v18, v22, v6 row_newbcast:4 row_mask:0xf bank_mask:0xf
    v_and_b32_dpp v19, v22, v7 row_newbcast:4 row_mask:0xf bank_mask:0xf
    s_waitcnt vmcnt(5)
    s_nop 0
    v_mfma_f32_16x16x32_bf16 v[8:11], v[16:19], v[104:107], v[8:11]
    s_bitcmp1_b32 s17, 15
    s_cbranch_scc1 L_PACE143
    s_waitcnt vmcnt(4)
L_PACE143:
    buffer_load_dwordx4 v[96:99], v2, s[8:11], s53 offen nt
    s_add_u32 s53, s53, s54
    v_and_b32_dpp v12, v22, v4 row_newbcast:8 row_mask:0xf bank_mask:0xf
    v_and_b32_dpp v13, v22, v5 row_newbcast:8 row_mask:0xf bank_mask:0xf
    v_and_b32_dpp v14, v22, v6 row_newbcast:8 row_mask:0xf bank_mask:0xf
    v_and_b32_dpp v15, v22, v7 row_newbcast:8 row_mask:0xf bank_mask:0xf
    s_waitcnt vmcnt(5)
    s_nop 0
    v_mfma_f32_16x16x32_bf16 v[8:11], v[12:15], v[108:111], v[8:11]
    s_bitcmp1_b32 s17, 16
    s_cbranch_scc1 L_PACE144
    s_waitcnt vmcnt(4)
L_PACE144:
    buffer_load_dwordx4 v[100:103], v2, s[8:11], s53 offen nt
    s_add_u32 s53, s53, s54
    v_and_b32_dpp v16, v22, v4 row_newbcast:12 row_mask:0xf bank_mask:0xf
    v_and_b32_dpp v17, v22, v5 row_newbcast:12 row_mask:0xf bank_mask:0xf
    v_and_b32_dpp v18, v22, v6 row_newbcast:12 row_mask:0xf bank_mask:0xf
    v_and_b32_dpp v19, v22, v7 row_newbcast:12 row_mask:0xf bank_mask:0xf
    s_waitcnt vmcnt(5)
    s_nop 0
    v_mfma_f32_16x16x32_bf16 v[8:11], v[16:19], v[112:115], v[8:11]
    s_bitcmp1_b32 s17, 17
    s_cbranch_scc1 L_PACE145
    s_waitcnt vmcnt(4)
L_PACE145:
    buffer_load_dwordx4 v[104:107], v2, s[8:11], s53 offen nt
    s_add_u32 s53, s53, s54
    v_and_b32_dpp v12, v23, v4 row_newbcast:0 row_mask:0xf bank_mask:0xf
    v_and_b32_dpp v13, v23, v5 row_newbcast:0 row_mask:0xf bank_mask:0xf
    v_and_b32_dpp v14, v23, v6 row_newbcast:0 row_mask:0xf bank_mask:0xf
    v_and_b32_dpp v15, v23, v7 row_newbcast:0 row_mask:0xf bank_mask:0xf
    s_waitcnt vmcnt(5)
    s_nop 0
    v_mfma_f32_16x16x32_bf16 v[8:11], v[12:15], v[116:119], v[8:11]
    s_bitcmp1_b32 s17, 18
    s_cbranch_scc1 L_PACE146
    s_waitcnt vmcnt(4)
L_PACE146:
    buffer_load_dwordx4 v[108:111], v2, s[8:11], s53 offen nt
    s_add_u32 s53, s53, s54
    v_and_b32_dpp v16, v23, v4 row_newbcast:4 row_mask:0xf bank_mask:0xf
    v_and_b32_dpp v17, v23, v5 row_newbcast:4 row_mask:0xf bank_mask:0xf
    v_and_b32_dpp v18, v23, v6 row_newbcast:4 row_mask:0xf bank_mask:0xf
    v_and_b32_dpp v19, v23, v7 row_newbcast:4 row_mask:0xf bank_mask:0xf
    s_waitcnt vmcnt(5)
    s_nop 0
    v_mfma_f32_16x16x32_bf16 v[8:11], v[16:19], v[120:123], v[8:11]
    s_bitcmp1_b32 s17, 19
    s_cbranch_scc1 L_PACE147
    s_waitcnt vmcnt(4)
L_PACE147:
    buffer_load_dwordx4 v[112:115], v2, s[8:11], s53 offen nt
    s_add_u32 s53, s53, s54
    v_and_b32_dpp v12, v23, v4 row_newbcast:8 row_mask:0xf bank_mask:0xf
    v_and_b32_dpp v13, v23, v5 row_newbcast:8 row_mask:0xf bank_mask:0xf
    v_and_b32_dpp v14, v23, v6 row_newbcast:8 row_mask:0xf bank_mask:0xf
    v_and_b32_dpp v15, v23, v7 row_newbcast:8 row_mask:0xf bank_mask:0xf
    s_waitcnt vmcnt(5)
    s_nop 0
    v_mfma_f32_16x16x32_bf16 v[8:11], v[12:15], v[124:127], v[8:11]
    s_bitcmp1_b32 s17, 20
    s_cbranch_scc1 L_PACE148
    s_waitcnt vmcnt(4)
L_PACE148:
    buffer_load_dwordx4 v[116:119], v2, s[8:11], s53 offen nt
    s_add_u32 s53, s53, s54
    v_and_b32_dpp v16, v23, v4 row_newbcast:12 row_mask:0xf bank_mask:0xf
    v_and_b32_dpp v17, v23, v5 row_newbcast:12 row_mask:0xf bank_mask:0xf
    v_and_b32_dpp v18, v23, v6 row_newbcast:12 row_mask:0xf bank_mask:0xf
    v_and_b32_dpp v19, v23, v7 row_newbcast:12 row_mask:0xf bank_mask:0xf
    s_waitcnt vmcnt(5)
    s_nop 0
    v_mfma_f32_16x16x32_bf16 v[8:11], v[16:19], v[96:99], v[8:11]
    s_bitcmp1_b32 s17, 21
    s_cbranch_scc1 L_PACE149
    s_waitcnt vmcnt(4)
L_PACE149:
    buffer_load_dwordx4 v[120:123], v2, s[8:11], s53 offen nt
    s_add_u32 s53, s53, s54
    v_and_b32_dpp v12, v24, v4 row_newbcast:0 row_mask:0xf bank_mask:0xf
    v_and_b32_dpp v13, v24, v5 row_newbcast:0 row_mask:0xf bank_mask:0xf
    v_and_b32_dpp v14, v24, v6 row_newbcast:0 row_mask:0xf bank_mask:0xf
    v_and_b32_dpp v15, v24, v7 row_newbcast:0 row_mask:0xf bank_mask:0xf
    s_waitcnt vmcnt(5)
    s_nop 0
    v_mfma_f32_16x16x32_bf16 v[8:11], v[12:15], v[100:103], v[8:11]
    s_bitcmp1_b32 s17, 22
    s_cbranch_scc1 L_PACE150
    s_waitcnt vmcnt(4)
L_PACE150:
    buffer_load_dwordx4 v[124:127], v2, s[8:11], s53 offen nt
    s_add_u32 s53, s53, s54
    v_and_b32_dpp v16, v24, v4 row_newbcast:4 row_mask:0xf bank_mask:0xf
    v_and_b32_dpp v17, v24, v5 row_newbcast:4 row_mask:0xf bank_mask:0xf
    v_and_b32_dpp v18, v24, v6 row_newbcast:4 row_mask:0xf bank_mask:0xf
    v_and_b32_dpp v19, v24, v7 row_newbcast:4 row_mask:0xf bank_mask:0xf
    s_waitcnt vmcnt(5)
    s_nop 0
    v_mfma_f32_16x16x32_bf16 v[8:11], v[16:19], v[104:107], v[8:11]
    s_bitcmp1_b32 s17, 23
    s_cbranch_scc1 L_PACE151
    s_waitcnt vmcnt(4)
L_PACE151:
    buffer_load_dwordx4 v[96:99], v2, s[8:11], s53 offen nt
    s_add_u32 s53, s53, s54
    v_and_b32_dpp v12, v24, v4 row_newbcast:8 row_mask:0xf bank_mask:0xf
    v_and_b32_dpp v13, v24, v5 row_newbcast:8 row_mask:0xf bank_mask:0xf
    v_and_b32_dpp v14, v24, v6 row_newbcast:8 row_mask:0xf bank_mask:0xf
    v_and_b32_dpp v15, v24, v7 row_newbcast:8 row_mask:0xf bank_mask:0xf
    s_waitcnt vmcnt(5)
    s_nop 0
    v_mfma_f32_16x16x32_bf16 v[8:11], v[12:15], v[108:111], v[8:11]
    s_bitcmp1_b32 s17, 24
    s_cbranch_scc1 L_PACE152
    s_waitcnt vmcnt(4)
L_PACE152:
    buffer_load_dwordx4 v[100:103], v2, s[8:11], s53 offen nt
    s_add_u32 s53, s53, s54
    v_and_b32_dpp v16, v24, v4 row_newbcast:12 row_mask:0xf bank_mask:0xf
    v_and_b32_dpp v17, v24, v5 row_newbcast:12 row_mask:0xf bank_mask:0xf
    v_and_b32_dpp v18, v24, v6 row_newbcast:12 row_mask:0xf bank_mask:0xf
    v_and_b32_dpp v19, v24, v7 row_newbcast:12 row_mask:0xf bank_mask:0xf
    s_waitcnt vmcnt(5)
    s_nop 0
    v_mfma_f32_16x16x32_bf16 v[8:11], v[16:19], v[112:115], v[8:11]
    s_bitcmp1_b32 s17, 25
    s_cbranch_scc1 L_PACE153
    s_waitcnt vmcnt(4)
L_PACE153:
    buffer_load_dwordx4 v[104:107], v2, s[8:11], s53 offen nt
    s_add_u32 s53, s53, s54
    v_and_b32_dpp v12, v25, v4 row_newbcast:0 row_mask:0xf bank_mask:0xf
    v_and_b32_dpp v13, v25, v5 row_newbcast:0 row_mask:0xf bank_mask:0xf
    v_and_b32_dpp v14, v25, v6 row_newbcast:0 row_mask:0xf bank_mask:0xf
    v_and_b32_dpp v15, v25, v7 row_newbcast:0 row_mask:0xf bank_mask:0xf
    s_waitcnt vmcnt(5)
    s_nop 0
    v_mfma_f32_16x16x32_bf16 v[8:11], v[12:15], v[116:119], v[8:11]
    s_bitcmp1_b32 s17, 26
    s_cbranch_scc1 L_PACE154
    s_waitcnt vmcnt(4)
L_PACE154:
    buffer_load_dwordx4 v[108:111], v2, s[8:11], s53 offen nt
    s_add_u32 s53, s53, s54
    v_and_b32_dpp v16, v25, v4 row_newbcast:4 row_mask:0xf bank_mask:0xf
    v_and_b32_dpp v17, v25, v5 row_newbcast:4 row_mask:0xf bank_mask:0xf
    v_and_b32_dpp v18, v25, v6 row_newbcast:4 row_mask:0xf bank_mask:0xf
    v_and_b32_dpp v19, v25, v7 row_newbcast:4 row_mask:0xf bank_mask:0xf
    s_waitcnt vmcnt(5)
    s_nop 0
    v_mfma_f32_16x16x32_bf16 v[8:11], v[16:19], v[120:123], v[8:11]
    s_bitcmp1_b32 s17, 27
    s_cbranch_scc1 L_PACE155
    s_waitcnt vmcnt(4)
L_PACE155:
    buffer_load_dwordx4 v[112:115], v2, s[8:11], s53 offen nt
    s_add_u32 s53, s53, s54
    v_and_b32_dpp v12, v25, v4 row_newbcast:8 row_mask:0xf bank_mask:0xf
    v_and_b32_dpp v13, v25, v5 row_newbcast:8 row_mask:0xf bank_mask:0xf
    v_and_b32_dpp v14, v25, v6 row_newbcast:8 row_mask:0xf bank_mask:0xf
    v_and_b32_dpp v15, v25, v7 row_newbcast:8 row_mask:0xf bank_mask:0xf
    s_waitcnt vmcnt(5)
    s_nop 0
    v_mfma_f32_16x16x32_bf16 v[8:11], v[12:15], v[124:127], v[8:11]
    s_bitcmp1_b32 s17, 28
    s_cbranch_scc1 L_PACE156
    s_waitcnt vmcnt(4)
L_PACE156:
    buffer_load_dwordx4 v[116:119], v2, s[8:11], s53 offen nt
    s_add_u32 s53, s53, s54
    v_and_b32_dpp v16, v25, v4 row_newbcast:12 row_mask:0xf bank_mask:0xf
    v_and_b32_dpp v17, v25, v5 row_newbcast:12 row_mask:0xf bank_mask:0xf
    v_and_b32_dpp v18, v25, v6 row_newbcast:12 row_mask:0xf bank_mask:0xf
    v_and_b32_dpp v19, v25, v7 row_newbcast:12 row_mask:0xf bank_mask:0xf
    s_waitcnt vmcnt(5)
    s_nop 0
    v_mfma_f32_16x16x32_bf16 v[8:11], v[16:19], v[96:99], v[8:11]
    s_bitcmp1_b32 s17, 29
    s_cbranch_scc1 L_PACE157
    s_waitcnt vmcnt(4)
L_PACE157:
    buffer_load_dwordx4 v[120:123], v2, s[8:11], s53 offen nt
    s_add_u32 s53, s53, s54
    v_and_b32_dpp v12, v26, v4 row_newbcast:0 row_mask:0xf bank_mask:0xf
    v_and_b32_dpp v13, v26, v5 row_newbcast:0 row_mask:0xf bank_mask:0xf
    v_and_b32_dpp v14, v26, v6 row_newbcast:0 row_mask:0xf bank_mask:0xf
    v_and_b32_dpp v15, v26, v7 row_newbcast:0 row_mask:0xf bank_mask:0xf
    s_waitcnt vmcnt(5)
    s_nop 0
    v_mfma_f32_16x16x32_bf16 v[8:11], v[12:15], v[100:103], v[8:11]
    s_bitcmp1_b32 s17, 30
    s_cbranch_scc1 L_PACE158
    s_waitcnt vmcnt(4)
L_PACE158:
    buffer_load_dwordx4 v[124:127], v2, s[8:11], s53 offen nt
    s_add_u32 s53, s53, s54
    v_and_b32_dpp v16, v26, v4 row_newbcast:4 row_mask:0xf bank_mask:0xf
    v_and_b32_dpp v17, v26, v5 row_newbcast:4 row_mask:0xf bank_mask:0xf
    v_and_b32_dpp v18, v26, v6 row_newbcast:4 row_mask:0xf bank_mask:0xf
    v_and_b32_dpp v19, v26, v7 row_newbcast:4 row_mask:0xf bank_mask:0xf
    s_waitcnt vmcnt(5)
    s_nop 0
    v_mfma_f32_16x16x32_bf16 v[8:11], v[16:19], v[104:107], v[8:11]
    s_bitcmp1_b32 s17, 31
    s_cbranch_scc1 L_PACE159
    s_waitcnt vmcnt(4)
L_PACE159:
    buffer_load_dwordx4 v[96:99], v2, s[8:11], s53 offen nt
    s_add_u32 s53, s53, s54
    v_and_b32_dpp v12, v26, v4 row_newbcast:8 row_mask:0xf bank_mask:0xf
    v_and_b32_dpp v13, v26, v5 row_newbcast:8 row_mask:0xf bank_mask:0xf
    v_and_b32_dpp v14, v26, v6 row_newbcast:8 row_mask:0xf bank_mask:0xf
    v_and_b32_dpp v15, v26, v7 row_newbcast:8 row_mask:0xf bank_mask:0xf
    s_waitcnt vmcnt(5)
    s_nop 0
    v_mfma_f32_16x16x32_bf16 v[8:11], v[12:15], v[108:111], v[8:11]
    s_bitcmp1_b32 s17, 0
    s_cbranch_scc1 L_PACE160
    s_waitcnt vmcnt(4)
L_PACE160:
    buffer_load_dwordx4 v[100:103], v2, s[8:11], s53 offen nt
    s_add_u32 s53, s53, s54
    v_and_b32_dpp v16, v26, v4 row_newbcast:12 row_mask:0xf bank_mask:0xf
    v_and_b32_dpp v17, v26, v5 row_newbcast:12 row_mask:0xf bank_mask:0xf
    v_and_b32_dpp v18, v26, v6 row_newbcast:12 row_mask:0xf bank_mask:0xf
    v_and_b32_dpp v19, v26, v7 row_newbcast:12 row_mask:0xf bank_mask:0xf
    s_waitcnt vmcnt(5)
    s_nop 0
    v_mfma_f32_16x16x32_bf16 v[8:11], v[16:19], v[112:115], v[8:11]
    s_bitcmp1_b32 s17, 1
    s_cbranch_scc1 L_PACE161
    s_waitcnt vmcnt(4)
L_PACE161:
    buffer_load_dwordx4 v[104:107], v2, s[8:11], s53 offen nt
    s_add_u32 s53, s53, s54
    v_and_b32_dpp v12, v27, v4 row_newbcast:0 row_mask:0xf bank_mask:0xf
    v_and_b32_dpp v13, v27, v5 row_newbcast:0 row_mask:0xf bank_mask:0xf
    v_and_b32_dpp v14, v27, v6 row_newbcast:0 row_mask:0xf bank_mask:0xf
    v_and_b32_dpp v15, v27, v7 row_newbcast:0 row_mask:0xf bank_mask:0xf
    s_waitcnt vmcnt(5)
    s_nop 0
    v_mfma_f32_16x16x32_bf16 v[8:11], v[12:15], v[116:119], v[8:11]
    s_bitcmp1_b32 s17, 2
    s_cbranch_scc1 L_PACE162
    s_waitcnt vmcnt(4)
L_PACE162:
    buffer_load_dwordx4 v[108:111], v2, s[8:11], s53 offen nt
    s_add_u32 s53, s53, s54
    v_and_b32_dpp v16, v27, v4 row_newbcast:4 row_mask:0xf bank_mask:0xf
    v_and_b32_dpp v17, v27, v5 row_newbcast:4 row_mask:0xf bank_mask:0xf
    v_and_b32_dpp v18, v27, v6 row_newbcast:4 row_mask:0xf bank_mask:0xf
    v_and_b32_dpp v19, v27, v7 row_newbcast:4 row_mask:0xf bank_mask:0xf
    s_waitcnt vmcnt(5)
    s_nop 0
    v_mfma_f32_16x16x32_bf16 v[8:11], v[16:19], v[120:123], v[8:11]
    s_bitcmp1_b32 s17, 3
    s_cbranch_scc1 L_PACE163
    s_waitcnt vmcnt(4)
L_PACE163:
    buffer_load_dwordx4 v[112:115], v2, s[8:11], s53 offen nt
    s_add_u32 s53, s53, s54
    v_and_b32_dpp v12, v27, v4 row_newbcast:8 row_mask:0xf bank_mask:0xf
    v_and_b32_dpp v13, v27, v5 row_newbcast:8 row_mask:0xf bank_mask:0xf
    v_and_b32_dpp v14, v27, v6 row_newbcast:8 row_mask:0xf bank_mask:0xf
    v_and_b32_dpp v15, v27, v7 row_newbcast:8 row_mask:0xf bank_mask:0xf
    s_waitcnt vmcnt(5)
    s_nop 0
    v_mfma_f32_16x16x32_bf16 v[8:11], v[12:15], v[124:127], v[8:11]
    s_add_u32 s59, s58, 0
    buffer_load_dwordx4 v[64:67], v3, s[12:15], s59 offen offset:0
    s_bitcmp1_b32 s17, 4
    s_cbranch_scc1 L_PACE164
    s_waitcnt vmcnt(5)
L_PACE164:
    buffer_load_dwordx4 v[116:119], v2, s[8:11], s53 offen nt
    s_add_u32 s53, s53, s54
    v_and_b32_dpp v16, v27, v4 row_newbcast:12 row_mask:0xf bank_mask:0xf
    v_and_b32_dpp v17, v27, v5 row_newbcast:12 row_mask:0xf bank_mask:0xf
    v_and_b32_dpp v18, v27, v6 row_newbcast:12 row_mask:0xf bank_mask:0xf
    v_and_b32_dpp v19, v27, v7 row_newbcast:12 row_mask:0xf bank_mask:0xf
    s_waitcnt vmcnt(6)
    s_nop 0
    v_mfma_f32_16x16x32_bf16 v[8:11], v[16:19], v[96:99], v[8:11]
    s_bitcmp1_b32 s17, 5
    s_cbranch_scc1 L_PACE165
    s_waitcnt vmcnt(5)
L_PACE165:
    buffer_load_dwordx4 v[120:123], v2, s[8:11], s53 offen nt
    s_add_u32 s53, s53, s54
    v_and_b32_dpp v12, v28, v4 row_newbcast:0 row_mask:0xf bank_mask:0xf
    v_and_b32_dpp v13, v28, v5 row_newbcast:0 row_mask:0xf bank_mask:0xf
    v_and_b32_dpp v14, v28, v6 row_newbcast:0 row_mask:0xf bank_mask:0xf
    v_and_b32_dpp v15, v28, v7 row_newbcast:0 row_mask:0xf bank_mask:0xf
    s_waitcnt vmcnt(6)
    s_nop 0
    v_mfma_f32_16x16x32_bf16 v[8:11], v[12:15], v[100:103], v[8:11]
    buffer_load_dwordx4 v[68:71], v3, s[12:15], s59 offen offset:1024
    s_bitcmp1_b32 s17, 6
    s_cbranch_scc1 L_PACE166
    s_waitcnt vmcnt(6)
L_PACE166:
    buffer_load_dwordx4 v[124:127], v2, s[8:11], s53 offen nt
    s_add_u32 s53, s53, s54
    v_and_b32_dpp v16, v28, v4 row_newbcast:4 row_mask:0xf bank_mask:0xf
    v_and_b32_dpp v17, v28, v5 row_newbcast:4 row_mask:0xf bank_mask:0xf
    v_and_b32_dpp v18, v28, v6 row_newbcast:4 row_mask:0xf bank_mask:0xf
    v_and_b32_dpp v19, v28, v7 row_newbcast:4 row_mask:0xf bank_mask:0xf
    s_waitcnt vmcnt(7)
    s_nop 0
    v_mfma_f32_16x16x32_bf16 v[8:11], v[16:19], v[104:107], v[8:11]
    s_bitcmp1_b32 s17, 7
    s_cbranch_scc1 L_PACE167
    s_waitcnt vmcnt(6)
L_PACE167:
    buffer_load_dwordx4 v[96:99], v2, s[8:11], s53 offen nt
    s_add_u32 s53, s53, s54
    v_and_b32_dpp v12, v28, v4 row_newbcast:8 row_mask:0xf bank_mask:0xf
    v_and_b32_dpp v13, v28, v5 row_newbcast:8 row_mask:0xf bank_mask:0xf
    v_and_b32_dpp v14, v28, v6 row_newbcast:8 row_mask:0xf bank_mask:0xf
    v_and_b32_dpp v15, v28, v7 row_newbcast:8 row_mask:0xf bank_mask:0xf
    s_waitcnt vmcnt(7)
    s_nop 0
    v_mfma_f32_16x16x32_bf16 v[8:11], v[12:15], v[108:111], v[8:11]
    buffer_load_dwordx4 v[72:75], v3, s[12:15], s59 offen offset:2048
    s_bitcmp1_b32 s17, 8
    s_cbranch_scc1 L_PACE168
    s_waitcnt vmcnt(7)
L_PACE168:
    buffer_load_dwordx4 v[100:103], v2, s[8:11], s53 offen nt
    s_add_u32 s53, s53, s54
    v_and_b32_dpp v16, v28, v4 row_newbcast:12 row_mask:0xf bank_mask:0xf
    v_and_b32_dpp v17, v28, v5 row_newbcast:12 row_mask:0xf bank_mask:0xf
    v_and_b32_dpp v18, v28, v6 row_newbcast:12 row_mask:0xf bank_mask:0xf
    v_and_b32_dpp v19, v28, v7 row_newbcast:12 row_mask:0xf bank_mask:0xf
    s_waitcnt vmcnt(8)
    s_nop 0
    v_mfma_f32_16x16x32_bf16 v[8:11], v[16:19], v[112:115], v[8:11]
    s_bitcmp1_b32 s17, 9
    s_cbranch_scc1 L_PACE169
    s_waitcnt vmcnt(6)
L_PACE169:
    buffer_load_dwordx4 v[104:107], v2, s[8:11], s53 offen nt
    s_add_u32 s53, s53, s54
    v_and_b32_dpp v12, v29, v4 row_newbcast:0 row_mask:0xf bank_mask:0xf
    v_and_b32_dpp v13, v29, v5 row_newbcast:0 row_mask:0xf bank_mask:0xf
    v_and_b32_dpp v14, v29, v6 row_newbcast:0 row_mask:0xf bank_mask:0xf
    v_and_b32_dpp v15, v29, v7 row_newbcast:0 row_mask:0xf bank_mask:0xf
    s_waitcnt vmcnt(7)
    s_nop 0
    v_mfma_f32_16x16x32_bf16 v[8:11], v[12:15], v[116:119], v[8:11]
    buffer_load_dwordx4 v[76:79], v3, s[12:15], s59 offen offset:3072
    s_bitcmp1_b32 s17, 10
    s_cbranch_scc1 L_PACE170
    s_waitcnt vmcnt(7)
L_PACE170:
    buffer_load_dwordx4 v[108:111], v2, s[8:11], s53 offen nt
    s_add_u32 s53, s53, s54
    v_and_b32_dpp v16, v29, v4 row_newbcast:4 row_mask:0xf bank_mask:0xf
    v_and_b32_dpp v17, v29, v5 row_newbcast:4 row_mask:0xf bank_mask:0xf
    v_and_b32_dpp v18, v29, v6 row_newbcast:4 row_mask:0xf bank_mask:0xf
    v_and_b32_dpp v19, v29, v7 row_newbcast:4 row_mask:0xf bank_mask:0xf
    s_waitcnt vmcnt(8)
    s_nop 0
    v_mfma_f32_16x16x32_bf16 v[8:11], v[16:19], v[120:123], v[8:11]
    s_bitcmp1_b32 s17, 11
    s_cbranch_scc1 L_PACE171
    s_waitcnt vmcnt(6)
L_PACE171:
    buffer_load_dwordx4 v[112:115], v2, s[8:11], s53 offen nt
    s_add_u32 s53, s53, s54
    v_and_b32_dpp v12, v29, v4 row_newbcast:8 row_mask:0xf bank_mask:0xf
    v_and_b32_dpp v13, v29, v5 row_newbcast:8 row_mask:0xf bank_mask:0xf
    v_and_b32_dpp v14, v29, v6 row_newbcast:8 row_mask:0xf bank_mask:0xf
    v_and_b32_dpp v15, v29, v7 row_newbcast:8 row_mask:0xf bank_mask:0xf
    s_waitcnt vmcnt(7)
    s_nop 0
    v_mfma_f32_16x16x32_bf16 v[8:11], v[12:15], v[124:127], v[8:11]
    v_perm_b32 v128, v68, v64, s56
    v_perm_b32 v132, v68, v64, s57
    v_perm_b32 v136, v69, v65, s56
    v_perm_b32 v140, v69, v65, s57
    v_perm_b32 v144, v70, v66, s56
    v_perm_b32 v148, v70, v66, s57
    v_perm_b32 v152, v71, v67, s56
    v_perm_b32 v156, v71, v67, s57
    s_add_u32 s59, s58, 4096
    buffer_load_dwordx4 v[80:83], v3, s[12:15], s59 offen offset:0
    s_bitcmp1_b32 s17, 12
    s_cbranch_scc1 L_PACE172
    s_waitcnt vmcnt(7)
L_PACE172:
    buffer_load_dwordx4 v[116:119], v2, s[8:11], s53 offen nt
    s_add_u32 s53, s53, s54
    v_and_b32_dpp v16, v29, v4 row_newbcast:12 row_mask:0xf bank_mask:0xf
    v_and_b32_dpp v17, v29, v5 row_newbcast:12 row_mask:0xf bank_mask:0xf
    v_and_b32_dpp v18, v29, v6 row_newbcast:12 row_mask:0xf bank_mask:0xf
    v_and_b32_dpp v19, v29, v7 row_newbcast:12 row_mask:0xf bank_mask:0xf
    s_waitcnt vmcnt(8)
    s_nop 0
    v_mfma_f32_16x16x32_bf16 v[8:11], v[16:19], v[96:99], v[8:11]
    s_bitcmp1_b32 s17, 13
    s_cbranch_scc1 L_PACE173
    s_waitcnt vmcnt(6)
L_PACE173:
    buffer_load_dwordx4 v[120:123], v2, s[8:11], s53 offen nt
    s_add_u32 s53, s53, s54
    v_and_b32_dpp v12, v30, v4 row_newbcast:0 row_mask:0xf bank_mask:0xf
    v_and_b32_dpp v13, v30, v5 row_newbcast:0 row_mask:0xf bank_mask:0xf
    v_and_b32_dpp v14, v30, v6 row_newbcast:0 row_mask:0xf bank_mask:0xf
    v_and_b32_dpp v15, v30, v7 row_newbcast:0 row_mask:0xf bank_mask:0xf
    s_waitcnt vmcnt(7)
    s_nop 0
    v_mfma_f32_16x16x32_bf16 v[8:11], v[12:15], v[100:103], v[8:11]
    buffer_load_dwordx4 v[84:87], v3, s[12:15], s59 offen offset:1024
    s_bitcmp1_b32 s17, 14
    s_cbranch_scc1 L_PACE174
    s_waitcnt vmcnt(7)
L_PACE174:
    buffer_load_dwordx4 v[124:127], v2, s[8:11], s53 offen nt
    s_add_u32 s53, s53, s54
    v_and_b32_dpp v16, v30, v4 row_newbcast:4 row_mask:0xf bank_mask:0xf
    v_and_b32_dpp v17, v30, v5 row_newbcast:4 row_mask:0xf bank_mask:0xf
    v_and_b32_dpp v18, v30, v6 row_newbcast:4 row_mask:0xf bank_mask:0xf
    v_and_b32_dpp v19, v30, v7 row_newbcast:4 row_mask:0xf bank_mask:0xf
    s_waitcnt vmcnt(8)
    s_nop 0
    v_mfma_f32_16x16x32_bf16 v[8:11], v[16:19], v[104:107], v[8:11]
    s_bitcmp1_b32 s17, 15
    s_cbranch_scc1 L_PACE175
    s_waitcnt vmcnt(6)
L_PACE175:
    buffer_load_dwordx4 v[96:99], v2, s[8:11], s53 offen nt
    s_add_u32 s53, s53, s54
    v_and_b32_dpp v12, v30, v4 row_newbcast:8 row_mask:0xf bank_mask:0xf
    v_and_b32_dpp v13, v30, v5 row_newbcast:8 row_mask:0xf bank_mask:0xf
    v_and_b32_dpp v14, v30, v6 row_newbcast:8 row_mask:0xf bank_mask:0xf
    v_and_b32_dpp v15, v30, v7 row_newbcast:8 row_mask:0xf bank_mask:0xf
    s_waitcnt vmcnt(7)
    s_nop 0
    v_mfma_f32_16x16x32_bf16 v[8:11], v[12:15], v[108:111], v[8:11]
    v_perm_b32 v129, v76, v72, s56
    v_perm_b32 v133, v76, v72, s57
    v_perm_b32 v137, v77, v73, s56
    v_perm_b32 v141, v77, v73, s57
    v_perm_b32 v145, v78, v74, s56
    v_perm_b32 v149, v78, v74, s57
    v_perm_b32 v153, v79, v75, s56
    v_perm_b32 v157, v79, v75, s57
    buffer_load_dwordx4 v[88:91], v3, s[12:15], s59 offen offset:2048
    s_bitcmp1_b32 s17, 16
    s_cbranch_scc1 L_PACE176
    s_waitcnt vmcnt(7)
L_PACE176:
    buffer_load_dwordx4 v[100:103], v2, s[8:11], s53 offen nt
    s_add_u32 s53, s53, s54
    v_and_b32_dpp v16, v30, v4 row_newbcast:12 row_mask:0xf bank_mask:0xf
    v_and_b32_dpp v17, v30, v5 row_newbcast:12 row_mask:0xf bank_mask:0xf
    v_and_b32_dpp v18, v30, v6 row_newbcast:12 row_mask:0xf bank_mask:0xf
    v_and_b32_dpp v19, v30, v7 row_newbcast:12 row_mask:0xf bank_mask:0xf
    s_waitcnt vmcnt(8)
    s_nop 0
    v_mfma_f32_16x16x32_bf16 v[8:11], v[16:19], v[112:115], v[8:11]
    s_bitcmp1_b32 s17, 17
    s_cbranch_scc1 L_PACE177
    s_waitcnt vmcnt(6)
L_PACE177:
    buffer_load_dwordx4 v[104:107], v2, s[8:11], s53 offen nt
    s_add_u32 s53, s53, s54
    v_and_b32_dpp v12, v31, v4 row_newbcast:0 row_mask:0xf bank_mask:0xf
    v_and_b32_dpp v13, v31, v5 row_newbcast:0 row_mask:0xf bank_mask:0xf
    v_and_b32_dpp v14, v31, v6 row_newbcast:0 row_mask:0xf bank_mask:0xf
    v_and_b32_dpp v15, v31, v7 row_newbcast:0 row_mask:0xf bank_mask:0xf
    s_waitcnt vmcnt(7)
    s_nop 0
    v_mfma_f32_16x16x32_bf16 v[8:11], v[12:15], v[116:119], v[8:11]
    buffer_load_dwordx4 v[92:95], v3, s[12:15], s59 offen offset:3072
    s_bitcmp1_b32 s17, 18
    s_cbranch_scc1 L_PACE178
    s_waitcnt vmcnt(7)
L_PACE178:
    buffer_load_dwordx4 v[108:111], v2, s[8:11], s53 offen nt
    s_add_u32 s53, s53, s54
    v_and_b32_dpp v16, v31, v4 row_newbcast:4 row_mask:0xf bank_mask:0xf
    v_and_b32_dpp v17, v31, v5 row_newbcast:4 row_mask:0xf bank_mask:0xf
    v_and_b32_dpp v18, v31, v6 row_newbcast:4 row_mask:0xf bank_mask:0xf
    v_and_b32_dpp v19, v31, v7 row_newbcast:4 row_mask:0xf bank_mask:0xf
    s_waitcnt vmcnt(8)
    s_nop 0
    v_mfma_f32_16x16x32_bf16 v[8:11], v[16:19], v[120:123], v[8:11]
    s_bitcmp1_b32 s17, 19
    s_cbranch_scc1 L_PACE179
    s_waitcnt vmcnt(6)
L_PACE179:
    buffer_load_dwordx4 v[112:115], v2, s[8:11], s53 offen nt
    s_add_u32 s53, s53, s54
    v_and_b32_dpp v12, v31, v4 row_newbcast:8 row_mask:0xf bank_mask:0xf
    v_and_b32_dpp v13, v31, v5 row_newbcast:8 row_mask:0xf bank_mask:0xf
    v_and_b32_dpp v14, v31, v6 row_newbcast:8 row_mask:0xf bank_mask:0xf
    v_and_b32_dpp v15, v31, v7 row_newbcast:8 row_mask:0xf bank_mask:0xf
    s_waitcnt vmcnt(7)
    s_nop 0
    v_mfma_f32_16x16x32_bf16 v[8:11], v[12:15], v[124:127], v[8:11]
    v_perm_b32 v130, v84, v80, s56
    v_perm_b32 v134, v84, v80, s57
    v_perm_b32 v138, v85, v81, s56
    v_perm_b32 v142, v85, v81, s57
    v_perm_b32 v146, v86, v82, s56
    v_perm_b32 v150, v86, v82, s57
    v_perm_b32 v154, v87, v83, s56
    v_perm_b32 v158, v87, v83, s57
    s_add_u32 s59, s58, 32768
    buffer_load_dwordx4 v[64:67], v3, s[12:15], s59 offen offset:0
    s_bitcmp1_b32 s17, 20
    s_cbranch_scc1 L_PACE180
    s_waitcnt vmcnt(7)
L_PACE180:
    buffer_load_dwordx4 v[116:119], v2, s[8:11], s53 offen nt
    s_add_u32 s53, s53, s54
    v_and_b32_dpp v16, v31, v4 row_newbcast:12 row_mask:0xf bank_mask:0xf
    v_and_b32_dpp v17, v31, v5 row_newbcast:12 row_mask:0xf bank_mask:0xf
    v_and_b32_dpp v18, v31, v6 row_newbcast:12 row_mask:0xf bank_mask:0xf
    v_and_b32_dpp v19, v31, v7 row_newbcast:12 row_mask:0xf bank_mask:0xf
    s_waitcnt vmcnt(8)
    s_nop 0
    v_mfma_f32_16x16x32_bf16 v[8:11], v[16:19], v[96:99], v[8:11]
    s_bitcmp1_b32 s17, 21
    s_cbranch_scc1 L_PACE181
    s_waitcnt vmcnt(6)
L_PACE181:
    buffer_load_dwordx4 v[120:123], v2, s[8:11], s53 offen nt
    s_add_u32 s53, s53, s54
    v_and_b32_dpp v12, v32, v4 row_newbcast:0 row_mask:0xf bank_mask:0xf
    v_and_b32_dpp v13, v32, v5 row_newbcast:0 row_mask:0xf bank_mask:0xf
    v_and_b32_dpp v14, v32, v6 row_newbcast:0 row_mask:0xf bank_mask:0xf
    v_and_b32_dpp v15, v32, v7 row_newbcast:0 row_mask:0xf bank_mask:0xf
    s_waitcnt vmcnt(7)
    s_nop 0
    v_mfma_f32_16x16x32_bf16 v[8:11], v[12:15], v[100:103], v[8:11]
    buffer_load_dwordx4 v[68:71], v3, s[12:15], s59 offen offset:1024
    s_bitcmp1_b32 s17, 22
    s_cbranch_scc1 L_PACE182
    s_waitcnt vmcnt(7)
L_PACE182:
    buffer_load_dwordx4 v[124:127], v2, s[8:11], s53 offen nt
    s_add_u32 s53, s53, s54
    v_and_b32_dpp v16, v32, v4 row_newbcast:4 row_mask:0xf bank_mask:0xf
    v_and_b32_dpp v17, v32, v5 row_newbcast:4 row_mask:0xf bank_mask:0xf
    v_and_b32_dpp v18, v32, v6 row_newbcast:4 row_mask:0xf bank_mask:0xf
    v_and_b32_dpp v19, v32, v7 row_newbcast:4 row_mask:0xf bank_mask:0xf
    s_waitcnt vmcnt(8)
    s_nop 0
    v_mfma_f32_16x16x32_bf16 v[8:11], v[16:19], v[104:107], v[8:11]
    s_bitcmp1_b32 s17, 23
    s_cbranch_scc1 L_PACE183
    s_waitcnt vmcnt(6)
L_PACE183:
    buffer_load_dwordx4 v[96:99], v2, s[8:11], s53 offen nt
    s_add_u32 s53, s53, s54
    v_and_b32_dpp v12, v32, v4 row_newbcast:8 row_mask:0xf bank_mask:0xf
    v_and_b32_dpp v13, v32, v5 row_newbcast:8 row_mask:0xf bank_mask:0xf
    v_and_b32_dpp v14, v32, v6 row_newbcast:8 row_mask:0xf bank_mask:0xf
    v_and_b32_dpp v15, v32, v7 row_newbcast:8 row_mask:0xf bank_mask:0xf
    s_waitcnt vmcnt(7)
    s_nop 0
    v_mfma_f32_16x16x32_bf16 v[8:11], v[12:15], v[108:111], v[8:11]
    v_perm_b32 v131, v92, v88, s56
    v_perm_b32 v135, v92, v88, s57
    v_perm_b32 v139, v93, v89, s56
    v_perm_b32 v143, v93, v89, s57
    v_perm_b32 v147, v94, v90, s56
    v_perm_b32 v151, v94, v90, s57
    v_perm_b32 v155, v95, v91, s56
    v_perm_b32 v159, v95, v91, s57
    buffer_load_dwordx4 v[72:75], v3, s[12:15], s59 offen offset:2048
    s_bitcmp1_b32 s17, 24
    s_cbranch_scc1 L_PACE184
    s_waitcnt vmcnt(7)
L_PACE184:
    buffer_load_dwordx4 v[100:103], v2, s[8:11], s53 offen nt
    s_add_u32 s53, s53, s54
    v_and_b32_dpp v16, v32, v4 row_newbcast:12 row_mask:0xf bank_mask:0xf
    v_and_b32_dpp v17, v32, v5 row_newbcast:12 row_mask:0xf bank_mask:0xf
    v_and_b32_dpp v18, v32, v6 row_newbcast:12 row_mask:0xf bank_mask:0xf
    v_and_b32_dpp v19, v32, v7 row_newbcast:12 row_mask:0xf bank_mask:0xf
    s_waitcnt vmcnt(8)
    s_nop 0
    v_mfma_f32_16x16x32_bf16 v[8:11], v[16:19], v[112:115], v[8:11]
    s_bitcmp1_b32 s17, 25
    s_cbranch_scc1 L_PACE185
    s_waitcnt vmcnt(6)
L_PACE185:
    buffer_load_dwordx4 v[104:107], v2, s[8:11], s53 offen nt
    s_add_u32 s53, s53, s54
    v_and_b32_dpp v12, v33, v4 row_newbcast:0 row_mask:0xf bank_mask:0xf
    v_and_b32_dpp v13, v33, v5 row_newbcast:0 row_mask:0xf bank_mask:0xf
    v_and_b32_dpp v14, v33, v6 row_newbcast:0 row_mask:0xf bank_mask:0xf
    v_and_b32_dpp v15, v33, v7 row_newbcast:0 row_mask:0xf bank_mask:0xf
    s_waitcnt vmcnt(7)
    s_nop 0
    v_mfma_f32_16x16x32_bf16 v[8:11], v[12:15], v[116:119], v[8:11]
    buffer_load_dwordx4 v[76:79], v3, s[12:15], s59 offen offset:3072
    s_bitcmp1_b32 s17, 26
    s_cbranch_scc1 L_PACE186
    s_waitcnt vmcnt(7)
L_PACE186:
    buffer_load_dwordx4 v[108:111], v2, s[8:11], s53 offen nt
    s_add_u32 s53, s53, s54
    v_and_b32_dpp v16, v33, v4 row_newbcast:4 row_mask:0xf bank_mask:0xf
    v_and_b32_dpp v17, v33, v5 row_newbcast:4 row_mask:0xf bank_mask:0xf
    v_and_b32_dpp v18, v33, v6 row_newbcast:4 row_mask:0xf bank_mask:0xf
    v_and_b32_dpp v19, v33, v7 row_newbcast:4 row_mask:0xf bank_mask:0xf
    s_waitcnt vmcnt(8)
    s_nop 0
    v_mfma_f32_16x16x32_bf16 v[8:11], v[16:19], v[120:123], v[8:11]
    s_bitcmp1_b32 s17, 27
    s_cbranch_scc1 L_PACE187
    s_waitcnt vmcnt(6)
L_PACE187:
    buffer_load_dwordx4 v[112:115], v2, s[8:11], s53 offen nt
    s_add_u32 s53, s53, s54
    v_and_b32_dpp v12, v33, v4 row_newbcast:8 row_mask:0xf bank_mask:0xf
    v_and_b32_dpp v13, v33, v5 row_newbcast:8 row_mask:0xf bank_mask:0xf
    v_and_b32_dpp v14, v33, v6 row_newbcast:8 row_mask:0xf bank_mask:0xf
    v_and_b32_dpp v15, v33, v7 row_newbcast:8 row_mask:0xf bank_mask:0xf
    s_waitcnt vmcnt(7)
    s_nop 0
    v_mfma_f32_16x16x32_bf16 v[8:11], v[12:15], v[124:127], v[8:11]
    v_perm_b32 v160, v68, v64, s56
    v_perm_b32 v164, v68, v64, s57
    v_perm_b32 v168, v69, v65, s56
    v_perm_b32 v172, v69, v65, s57
    v_perm_b32 v176, v70, v66, s56
    v_perm_b32 v180, v70, v66, s57
    v_perm_b32 v184, v71, v67, s56
    v_perm_b32 v188, v71, v67, s57
    s_add_u32 s59, s58, 36864
    buffer_load_dwordx4 v[80:83], v3, s[12:15], s59 offen offset:0
    s_bitcmp1_b32 s17, 28
    s_cbranch_scc1 L_PACE188
    s_waitcnt vmcnt(7)
L_PACE188:
    buffer_load_dwordx4 v[116:119], v2, s[8:11], s53 offen nt
    s_add_u32 s53, s53, s54
    v_and_b32_dpp v16, v33, v4 row_newbcast:12 row_mask:0xf bank_mask:0xf
    v_and_b32_dpp v17, v33, v5 row_newbcast:12 row_mask:0xf bank_mask:0xf
    v_and_b32_dpp v18, v33, v6 row_newbcast:12 row_mask:0xf bank_mask:0xf
    v_and_b32_dpp v19, v33, v7 row_newbcast:12 row_mask:0xf bank_mask:0xf
    s_waitcnt vmcnt(8)
    s_nop 0
    v_mfma_f32_16x16x32_bf16 v[8:11], v[16:19], v[96:99], v[8:11]
    s_bitcmp1_b32 s17, 29
    s_cbranch_scc1 L_PACE189
    s_waitcnt vmcnt(6)
L_PACE189:
    buffer_load_dwordx4 v[120:123], v2, s[8:11], s53 offen nt
    s_add_u32 s53, s53, s54
    v_and_b32_dpp v12, v34, v4 row_newbcast:0 row_mask:0xf bank_mask:0xf
    v_and_b32_dpp v13, v34, v5 row_newbcast:0 row_mask:0xf bank_mask:0xf
    v_and_b32_dpp v14, v34, v6 row_newbcast:0 row_mask:0xf bank_mask:0xf
    v_and_b32_dpp v15, v34, v7 row_newbcast:0 row_mask:0xf bank_mask:0xf
    s_waitcnt vmcnt(7)
    s_nop 0
    v_mfma_f32_16x16x32_bf16 v[8:11], v[12:15], v[100:103], v[8:11]
    buffer_load_dwordx4 v[84:87], v3, s[12:15], s59 offen offset:1024
    s_bitcmp1_b32 s17, 30
    s_cbranch_scc1 L_PACE190
    s_waitcnt vmcnt(7)
L_PACE190:
    buffer_load_dwordx4 v[124:127], v2, s[8:11], s53 offen nt
    s_add_u32 s53, s53, s54
    v_and_b32_dpp v16, v34, v4 row_newbcast:4 row_mask:0xf bank_mask:0xf
    v_and_b32_dpp v17, v34, v5 row_newbcast:4 row_mask:0xf bank_mask:0xf
    v_and_b32_dpp v18, v34, v6 row_newbcast:4 row_mask:0xf bank_mask:0xf
    v_and_b32_dpp v19, v34, v7 row_newbcast:4 row_mask:0xf bank_mask:0xf
    s_waitcnt vmcnt(8)
    s_nop 0
    v_mfma_f32_16x16x32_bf16 v[8:11], v[16:19], v[104:107], v[8:11]
    s_bitcmp1_b32 s17, 31
    s_cbranch_scc1 L_PACE191
    s_waitcnt vmcnt(6)
L_PACE191:
    buffer_load_dwordx4 v[96:99], v2, s[8:11], s53 offen nt
    s_add_u32 s53, s53, s54
    v_and_b32_dpp v12, v34, v4 row_newbcast:8 row_mask:0xf bank_mask:0xf
    v_and_b32_dpp v13, v34, v5 row_newbcast:8 row_mask:0xf bank_mask:0xf
    v_and_b32_dpp v14, v34, v6 row_newbcast:8 row_mask:0xf bank_mask:0xf
    v_and_b32_dpp v15, v34, v7 row_newbcast:8 row_mask:0xf bank_mask:0xf
    s_waitcnt vmcnt(7)
    s_nop 0
    v_mfma_f32_16x16x32_bf16 v[8:11], v[12:15], v[108:111], v[8:11]
    v_perm_b32 v161, v76, v72, s56
    v_perm_b32 v165, v76, v72, s57
    v_perm_b32 v169, v77, v73, s56
    v_perm_b32 v173, v77, v73, s57
    v_perm_b32 v177, v78, v74, s56
    v_perm_b32 v181, v78, v74, s57
    v_perm_b32 v185, v79, v75, s56
    v_perm_b32 v189, v79, v75, s57
    buffer_load_dwordx4 v[88:91], v3, s[12:15], s59 offen offset:2048
    s_bitcmp1_b32 s17, 0
    s_cbranch_scc1 L_PACE192
    s_waitcnt vmcnt(7)
L_PACE192:
    buffer_load_dwordx4 v[100:103], v2, s[8:11], s53 offen nt
    s_add_u32 s53, s53, s54
    v_and_b32_dpp v16, v34, v4 row_newbcast:12 row_mask:0xf bank_mask:0xf
    v_and_b32_dpp v17, v34, v5 row_newbcast:12 row_mask:0xf bank_mask:0xf
    v_and_b32_dpp v18, v34, v6 row_newbcast:12 row_mask:0xf bank_mask:0xf
    v_and_b32_dpp v19, v34, v7 row_newbcast:12 row_mask:0xf bank_mask:0xf
    s_waitcnt vmcnt(8)
    s_nop 0
    v_mfma_f32_16x16x32_bf16 v[8:11], v[16:19], v[112:115], v[8:11]
    s_bitcmp1_b32 s17, 1
    s_cbranch_scc1 L_PACE193
    s_waitcnt vmcnt(6)
L_PACE193:
    buffer_load_dwordx4 v[104:107], v2, s[8:11], s53 offen nt
    s_add_u32 s53, s53, s54
    v_and_b32_dpp v12, v35, v4 row_newbcast:0 row_mask:0xf bank_mask:0xf
    v_and_b32_dpp v13, v35, v5 row_newbcast:0 row_mask:0xf bank_mask:0xf
    v_and_b32_dpp v14, v35, v6 row_newbcast:0 row_mask:0xf bank_mask:0xf
    v_and_b32_dpp v15, v35, v7 row_newbcast:0 row_mask:0xf bank_mask:0xf
    s_waitcnt vmcnt(7)
    s_nop 0
    v_mfma_f32_16x16x32_bf16 v[8:11], v[12:15], v[116:119], v[8:11]
    buffer_load_dwordx4 v[92:95], v3, s[12:15], s59 offen offset:3072
    s_bitcmp1_b32 s17, 2
    s_cbranch_scc1 L_PACE194
    s_waitcnt vmcnt(7)
L_PACE194:
    buffer_load_dwordx4 v[108:111], v2, s[8:11], s53 offen nt
    s_add_u32 s53, s53, s54
    v_and_b32_dpp v16, v35, v4 row_newbcast:4 row_mask:0xf bank_mask:0xf
    v_and_b32_dpp v17, v35, v5 row_newbcast:4 row_mask:0xf bank_mask:0xf
    v_and_b32_dpp v18, v35, v6 row_newbcast:4 row_mask:0xf bank_mask:0xf
    v_and_b32_dpp v19, v35, v7 row_newbcast:4 row_mask:0xf bank_mask:0xf
    s_waitcnt vmcnt(8)
    s_nop 0
    v_mfma_f32_16x16x32_bf16 v[8:11], v[16:19], v[120:123], v[8:11]
    s_bitcmp1_b32 s17, 3
    s_cbranch_scc1 L_PACE195
    s_waitcnt vmcnt(6)
L_PACE195:
    buffer_load_dwordx4 v[112:115], v2, s[8:11], s53 offen nt
    s_add_u32 s53, s53, s54
    v_and_b32_dpp v12, v35, v4 row_newbcast:8 row_mask:0xf bank_mask:0xf
    v_and_b32_dpp v13, v35, v5 row_newbcast:8 row_mask:0xf bank_mask:0xf
    v_and_b32_dpp v14, v35, v6 row_newbcast:8 row_mask:0xf bank_mask:0xf
    v_and_b32_dpp v15, v35, v7 row_newbcast:8 row_mask:0xf bank_mask:0xf
    s_waitcnt vmcnt(7)
    s_nop 0
    v_mfma_f32_16x16x32_bf16 v[8:11], v[12:15], v[124:127], v[8:11]
    v_perm_b32 v162, v84, v80, s56
    v_perm_b32 v166, v84, v80, s57
    v_perm_b32 v170, v85, v81, s56
    v_perm_b32 v174, v85, v81, s57
    v_perm_b32 v178, v86, v82, s56
    v_perm_b32 v182, v86, v82, s57
    v_perm_b32 v186, v87, v83, s56
    v_perm_b32 v190, v87, v83, s57
    s_add_u32 s59, s58, 65536
    buffer_load_dwordx4 v[64:67], v3, s[12:15], s59 offen offset:0
    s_bitcmp1_b32 s17, 4
    s_cbranch_scc1 L_PACE196
    s_waitcnt vmcnt(7)
L_PACE196:
    buffer_load_dwordx4 v[116:119], v2, s[8:11], s53 offen nt
    s_add_u32 s53, s53, s54
    v_and_b32_dpp v16, v35, v4 row_newbcast:12 row_mask:0xf bank_mask:0xf
    v_and_b32_dpp v17, v35, v5 row_newbcast:12 row_mask:0xf bank_mask:0xf
    v_and_b32_dpp v18, v35, v6 row_newbcast:12 row_mask:0xf bank_mask:0xf
    v_and_b32_dpp v19, v35, v7 row_newbcast:12 row_mask:0xf bank_mask:0xf
    s_waitcnt vmcnt(8)
    s_nop 0
    v_mfma_f32_16x16x32_bf16 v[8:11], v[16:19], v[96:99], v[8:11]
    s_bitcmp1_b32 s17, 5
    s_cbranch_scc1 L_PACE197
    s_waitcnt vmcnt(6)
L_PACE197:
    buffer_load_dwordx4 v[120:123], v2, s[8:11], s53 offen nt
    s_add_u32 s53, s53, s54
    v_and_b32_dpp v12, v36, v4 row_newbcast:0 row_mask:0xf bank_mask:0xf
    v_and_b32_dpp v13, v36, v5 row_newbcast:0 row_mask:0xf bank_mask:0xf
    v_and_b32_dpp v14, v36, v6 row_newbcast:0 row_mask:0xf bank_mask:0xf
    v_and_b32_dpp v15, v36, v7 row_newbcast:0 row_mask:0xf bank_mask:0xf
    s_waitcnt vmcnt(7)
    s_nop 0
    v_mfma_f32_16x16x32_bf16 v[8:11], v[12:15], v[100:103], v[8:11]
    buffer_load_dwordx4 v[68:71], v3, s[12:15], s59 offen offset:1024
    s_bitcmp1_b32 s17, 6
    s_cbranch_scc1 L_PACE198
    s_waitcnt vmcnt(7)
L_PACE198:
    buffer_load_dwordx4 v[124:127], v2, s[8:11], s53 offen nt
    s_add_u32 s53, s53, s54
    v_and_b32_dpp v16, v36, v4 row_newbcast:4 row_mask:0xf bank_mask:0xf
    v_and_b32_dpp v17, v36, v5 row_newbcast:4 row_mask:0xf bank_mask:0xf
    v_and_b32_dpp v18, v36, v6 row_newbcast:4 row_mask:0xf bank_mask:0xf
    v_and_b32_dpp v19, v36, v7 row_newbcast:4 row_mask:0xf bank_mask:0xf
    s_waitcnt vmcnt(8)
    s_nop 0
    v_mfma_f32_16x16x32_bf16 v[8:11], v[16:19], v[104:107], v[8:11]
    s_bitcmp1_b32 s17, 7
    s_cbranch_scc1 L_PACE199
    s_waitcnt vmcnt(6)
L_PACE199:
    buffer_load_dwordx4 v[96:99], v2, s[8:11], s53 offen nt
    s_add_u32 s53, s53, s54
    v_and_b32_dpp v12, v36, v4 row_newbcast:8 row_mask:0xf bank_mask:0xf
    v_and_b32_dpp v13, v36, v5 row_newbcast:8 row_mask:0xf bank_mask:0xf
    v_and_b32_dpp v14, v36, v6 row_newbcast:8 row_mask:0xf bank_mask:0xf
    v_and_b32_dpp v15, v36, v7 row_newbcast:8 row_mask:0xf bank_mask:0xf
    s_waitcnt vmcnt(7)
    s_nop 0
    v_mfma_f32_16x16x32_bf16 v[8:11], v[12:15], v[108:111], v[8:11]
    v_perm_b32 v163, v92, v88, s56
    v_perm_b32 v167, v92, v88, s57
    v_perm_b32 v171, v93, v89, s56
    v_perm_b32 v175, v93, v89, s57
    v_perm_b32 v179, v94, v90, s56
    v_perm_b32 v183, v94, v90, s57
    v_perm_b32 v187, v95, v91, s56
    v_perm_b32 v191, v95, v91, s57
    buffer_load_dwordx4 v[72:75], v3, s[12:15], s59 offen offset:2048
    s_bitcmp1_b32 s17, 8
    s_cbranch_scc1 L_PACE200
    s_waitcnt vmcnt(7)
L_PACE200:
    buffer_load_dwordx4 v[100:103], v2, s[8:11], s53 offen nt
    s_add_u32 s53, s53, s54
    v_and_b32_dpp v16, v36, v4 row_newbcast:12 row_mask:0xf bank_mask:0xf
    v_and_b32_dpp v17, v36, v5 row_newbcast:12 row_mask:0xf bank_mask:0xf
    v_and_b32_dpp v18, v36, v6 row_newbcast:12 row_mask:0xf bank_mask:0xf
    v_and_b32_dpp v19, v36, v7 row_newbcast:12 row_mask:0xf bank_mask:0xf
    s_waitcnt vmcnt(8)
    s_nop 0
    v_mfma_f32_16x16x32_bf16 v[8:11], v[16:19], v[112:115], v[8:11]
    s_bitcmp1_b32 s17, 9
    s_cbranch_scc1 L_PACE201
    s_waitcnt vmcnt(6)
L_PACE201:
    buffer_load_dwordx4 v[104:107], v2, s[8:11], s53 offen nt
    s_add_u32 s53, s53, s54
    v_and_b32_dpp v12, v37, v4 row_newbcast:0 row_mask:0xf bank_mask:0xf
    v_and_b32_dpp v13, v37, v5 row_newbcast:0 row_mask:0xf bank_mask:0xf
    v_and_b32_dpp v14, v37, v6 row_newbcast:0 row_mask:0xf bank_mask:0xf
    v_and_b32_dpp v15, v37, v7 row_newbcast:0 row_mask:0xf bank_mask:0xf
    s_waitcnt vmcnt(7)
    s_nop 0
    v_mfma_f32_16x16x32_bf16 v[8:11], v[12:15], v[116:119], v[8:11]
    buffer_load_dwordx4 v[76:79], v3, s[12:15], s59 offen offset:3072
    s_bitcmp1_b32 s17, 10
    s_cbranch_scc1 L_PACE202
    s_waitcnt vmcnt(7)
L_PACE202:
    buffer_load_dwordx4 v[108:111], v2, s[8:11], s53 offen nt
    s_add_u32 s53, s53, s54
    v_and_b32_dpp v16, v37, v4 row_newbcast:4 row_mask:0xf bank_mask:0xf
    v_and_b32_dpp v17, v37, v5 row_newbcast:4 row_mask:0xf bank_mask:0xf
    v_and_b32_dpp v18, v37, v6 row_newbcast:4 row_mask:0xf bank_mask:0xf
    v_and_b32_dpp v19, v37, v7 row_newbcast:4 row_mask:0xf bank_mask:0xf
    s_waitcnt vmcnt(8)
    s_nop 0
    v_mfma_f32_16x16x32_bf16 v[8:11], v[16:19], v[120:123], v[8:11]
    s_bitcmp1_b32 s17, 11
    s_cbranch_scc1 L_PACE203
    s_waitcnt vmcnt(6)
L_PACE203:
    buffer_load_dwordx4 v[112:115], v2, s[8:11], s53 offen nt
    s_add_u32 s53, s53, s54
    v_and_b32_dpp v12, v37, v4 row_newbcast:8 row_mask:0xf bank_mask:0xf
    v_and_b32_dpp v13, v37, v5 row_newbcast:8 row_mask:0xf bank_mask:0xf
    v_and_b32_dpp v14, v37, v6 row_newbcast:8 row_mask:0xf bank_mask:0xf
    v_and_b32_dpp v15, v37, v7 row_newbcast:8 row_mask:0xf bank_mask:0xf
    s_waitcnt vmcnt(7)
    s_nop 0
    v_mfma_f32_16x16x32_bf16 v[8:11], v[12:15], v[124:127], v[8:11]
    v_perm_b32 v192, v68, v64, s56
    v_perm_b32 v196, v68, v64, s57
    v_perm_b32 v200, v69, v65, s56
    v_perm_b32 v204, v69, v65, s57
    v_perm_b32 v208, v70, v66, s56
    v_perm_b32 v212, v70, v66, s57
    v_perm_b32 v216, v71, v67, s56
    v_perm_b32 v220, v71, v67, s57
    s_add_u32 s59, s58, 69632
    buffer_load_dwordx4 v[80:83], v3, s[12:15], s59 offen offset:0
    s_bitcmp1_b32 s17, 12
    s_cbranch_scc1 L_PACE204
    s_waitcnt vmcnt(7)
L_PACE204:
    buffer_load_dwordx4 v[116:119], v2, s[8:11], s53 offen nt
    s_add_u32 s53, s53, s54
    v_and_b32_dpp v16, v37, v4 row_newbcast:12 row_mask:0xf bank_mask:0xf
    v_and_b32_dpp v17, v37, v5 row_newbcast:12 row_mask:0xf bank_mask:0xf
    v_and_b32_dpp v18, v37, v6 row_newbcast:12 row_mask:0xf bank_mask:0xf
    v_and_b32_dpp v19, v37, v7 row_newbcast:12 row_mask:0xf bank_mask:0xf
    s_waitcnt vmcnt(8)
    s_nop 0
    v_mfma_f32_16x16x32_bf16 v[8:11], v[16:19], v[96:99], v[8:11]
    s_bitcmp1_b32 s17, 13
    s_cbranch_scc1 L_PACE205
    s_waitcnt vmcnt(6)
L_PACE205:
    buffer_load_dwordx4 v[120:123], v2, s[8:11], s53 offen nt
    s_add_u32 s53, s53, s54
    v_and_b32_dpp v12, v38, v4 row_newbcast:0 row_mask:0xf bank_mask:0xf
    v_and_b32_dpp v13, v38, v5 row_newbcast:0 row_mask:0xf bank_mask:0xf
    v_and_b32_dpp v14, v38, v6 row_newbcast:0 row_mask:0xf bank_mask:0xf
    v_and_b32_dpp v15, v38, v7 row_newbcast:0 row_mask:0xf bank_mask:0xf
    s_waitcnt vmcnt(7)
    s_nop 0
    v_mfma_f32_16x16x32_bf16 v[8:11], v[12:15], v[100:103], v[8:11]
    buffer_load_dwordx4 v[84:87], v3, s[12:15], s59 offen offset:1024
    s_bitcmp1_b32 s17, 14
    s_cbranch_scc1 L_PACE206
    s_waitcnt vmcnt(7)
L_PACE206:
    buffer_load_dwordx4 v[124:127], v2, s[8:11], s53 offen nt
    s_add_u32 s53, s53, s54
    v_and_b32_dpp v16, v38, v4 row_newbcast:4 row_mask:0xf bank_mask:0xf
    v_and_b32_dpp v17, v38, v5 row_newbcast:4 row_mask:0xf bank_mask:0xf
    v_and_b32_dpp v18, v38, v6 row_newbcast:4 row_mask:0xf bank_mask:0xf
    v_and_b32_dpp v19, v38, v7 row_newbcast:4 row_mask:0xf bank_mask:0xf
    s_waitcnt vmcnt(8)
    s_nop 0
    v_mfma_f32_16x16x32_bf16 v[8:11], v[16:19], v[104:107], v[8:11]
    s_bitcmp1_b32 s17, 15
    s_cbranch_scc1 L_PACE207
    s_waitcnt vmcnt(6)
L_PACE207:
    buffer_load_dwordx4 v[96:99], v2, s[8:11], s53 offen nt
    s_add_u32 s53, s53, s54
    v_and_b32_dpp v12, v38, v4 row_newbcast:8 row_mask:0xf bank_mask:0xf
    v_and_b32_dpp v13, v38, v5 row_newbcast:8 row_mask:0xf bank_mask:0xf
    v_and_b32_dpp v14, v38, v6 row_newbcast:8 row_mask:0xf bank_mask:0xf
    v_and_b32_dpp v15, v38, v7 row_newbcast:8 row_mask:0xf bank_mask:0xf
    s_waitcnt vmcnt(7)
    s_nop 0
    v_mfma_f32_16x16x32_bf16 v[8:11], v[12:15], v[108:111], v[8:11]
    v_perm_b32 v193, v76, v72, s56
    v_perm_b32 v197, v76, v72, s57
    v_perm_b32 v201, v77, v73, s56
    v_perm_b32 v205, v77, v73, s57
    v_perm_b32 v209, v78, v74, s56
    v_perm_b32 v213, v78, v74, s57
    v_perm_b32 v217, v79, v75, s56
    v_perm_b32 v221, v79, v75, s57
    buffer_load_dwordx4 v[88:91], v3, s[12:15], s59 offen offset:2048
    s_bitcmp1_b32 s17, 16
    s_cbranch_scc1 L_PACE208
    s_waitcnt vmcnt(7)
L_PACE208:
    buffer_load_dwordx4 v[100:103], v2, s[8:11], s53 offen nt
    s_add_u32 s53, s53, s54
    v_and_b32_dpp v16, v38, v4 row_newbcast:12 row_mask:0xf bank_mask:0xf
    v_and_b32_dpp v17, v38, v5 row_newbcast:12 row_mask:0xf bank_mask:0xf
    v_and_b32_dpp v18, v38, v6 row_newbcast:12 row_mask:0xf bank_mask:0xf
    v_and_b32_dpp v19, v38, v7 row_newbcast:12 row_mask:0xf bank_mask:0xf
    s_waitcnt vmcnt(8)
    s_nop 0
    v_mfma_f32_16x16x32_bf16 v[8:11], v[16:19], v[112:115], v[8:11]
    s_bitcmp1_b32 s17, 17
    s_cbranch_scc1 L_PACE209
    s_waitcnt vmcnt(6)
L_PACE209:
    buffer_load_dwordx4 v[104:107], v2, s[8:11], s53 offen nt
    s_add_u32 s53, s53, s54
    v_and_b32_dpp v12, v39, v4 row_newbcast:0 row_mask:0xf bank_mask:0xf
    v_and_b32_dpp v13, v39, v5 row_newbcast:0 row_mask:0xf bank_mask:0xf
    v_and_b32_dpp v14, v39, v6 row_newbcast:0 row_mask:0xf bank_mask:0xf
    v_and_b32_dpp v15, v39, v7 row_newbcast:0 row_mask:0xf bank_mask:0xf
    s_waitcnt vmcnt(7)
    s_nop 0
    v_mfma_f32_16x16x32_bf16 v[8:11], v[12:15], v[116:119], v[8:11]
    buffer_load_dwordx4 v[92:95], v3, s[12:15], s59 offen offset:3072
    s_bitcmp1_b32 s17, 18
    s_cbranch_scc1 L_PACE210
    s_waitcnt vmcnt(7)
L_PACE210:
    buffer_load_dwordx4 v[108:111], v2, s[8:11], s53 offen nt
    s_add_u32 s53, s53, s54
    v_and_b32_dpp v16, v39, v4 row_newbcast:4 row_mask:0xf bank_mask:0xf
    v_and_b32_dpp v17, v39, v5 row_newbcast:4 row_mask:0xf bank_mask:0xf
    v_and_b32_dpp v18, v39, v6 row_newbcast:4 row_mask:0xf bank_mask:0xf
    v_and_b32_dpp v19, v39, v7 row_newbcast:4 row_mask:0xf bank_mask:0xf
    s_waitcnt vmcnt(8)
    s_nop 0
    v_mfma_f32_16x16x32_bf16 v[8:11], v[16:19], v[120:123], v[8:11]
    s_bitcmp1_b32 s17, 19
    s_cbranch_scc1 L_PACE211
    s_waitcnt vmcnt(6)
L_PACE211:
    buffer_load_dwordx4 v[112:115], v2, s[8:11], s53 offen nt
    s_add_u32 s53, s53, s54
    v_and_b32_dpp v12, v39, v4 row_newbcast:8 row_mask:0xf bank_mask:0xf
    v_and_b32_dpp v13, v39, v5 row_newbcast:8 row_mask:0xf bank_mask:0xf
    v_and_b32_dpp v14, v39, v6 row_newbcast:8 row_mask:0xf bank_mask:0xf
    v_and_b32_dpp v15, v39, v7 row_newbcast:8 row_mask:0xf bank_mask:0xf
    s_waitcnt vmcnt(7)
    s_nop 0
    v_mfma_f32_16x16x32_bf16 v[8:11], v[12:15], v[124:127], v[8:11]
    v_perm_b32 v194, v84, v80, s56
    v_perm_b32 v198, v84, v80, s57
    v_perm_b32 v202, v85, v81, s56
    v_perm_b32 v206, v85, v81, s57
    v_perm_b32 v210, v86, v82, s56
    v_perm_b32 v214, v86, v82, s57
    v_perm_b32 v218, v87, v83, s56
    v_perm_b32 v222, v87, v83, s57
    s_add_u32 s59, s58, 98304
    buffer_load_dwordx4 v[64:67], v3, s[12:15], s59 offen offset:0
    s_bitcmp1_b32 s17, 20
    s_cbranch_scc1 L_PACE212
    s_waitcnt vmcnt(7)
L_PACE212:
    buffer_load_dwordx4 v[116:119], v2, s[8:11], s53 offen nt
    s_add_u32 s53, s53, s54
    v_and_b32_dpp v16, v39, v4 row_newbcast:12 row_mask:0xf bank_mask:0xf
    v_and_b32_dpp v17, v39, v5 row_newbcast:12 row_mask:0xf bank_mask:0xf
    v_and_b32_dpp v18, v39, v6 row_newbcast:12 row_mask:0xf bank_mask:0xf
    v_and_b32_dpp v19, v39, v7 row_newbcast:12 row_mask:0xf bank_mask:0xf
    s_waitcnt vmcnt(8)
    s_nop 0
    v_mfma_f32_16x16x32_bf16 v[8:11], v[16:19], v[96:99], v[8:11]
    s_bitcmp1_b32 s17, 21
    s_cbranch_scc1 L_PACE213
    s_waitcnt vmcnt(6)
L_PACE213:
    buffer_load_dwordx4 v[120:123], v2, s[8:11], s53 offen nt
    s_add_u32 s53, s53, s54
    v_and_b32_dpp v12, v40, v4 row_newbcast:0 row_mask:0xf bank_mask:0xf
    v_and_b32_dpp v13, v40, v5 row_newbcast:0 row_mask:0xf bank_mask:0xf
    v_and_b32_dpp v14, v40, v6 row_newbcast:0 row_mask:0xf bank_mask:0xf
    v_and_b32_dpp v15, v40, v7 row_newbcast:0 row_mask:0xf bank_mask:0xf
    s_waitcnt vmcnt(7)
    s_nop 0
    v_mfma_f32_16x16x32_bf16 v[8:11], v[12:15], v[100:103], v[8:11]
    buffer_load_dwordx4 v[68:71], v3, s[12:15], s59 offen offset:1024
    s_bitcmp1_b32 s17, 22
    s_cbranch_scc1 L_PACE214
    s_waitcnt vmcnt(7)
L_PACE214:
    buffer_load_dwordx4 v[124:127], v2, s[8:11], s53 offen nt
    s_add_u32 s53, s53, s54
    v_and_b32_dpp v16, v40, v4 row_newbcast:4 row_mask:0xf bank_mask:0xf
    v_and_b32_dpp v17, v40, v5 row_newbcast:4 row_mask:0xf bank_mask:0xf
    v_and_b32_dpp v18, v40, v6 row_newbcast:4 row_mask:0xf bank_mask:0xf
    v_and_b32_dpp v19, v40, v7 row_newbcast:4 row_mask:0xf bank_mask:0xf
    s_waitcnt vmcnt(8)
    s_nop 0
    v_mfma_f32_16x16x32_bf16 v[8:11], v[16:19], v[104:107], v[8:11]
    s_bitcmp1_b32 s17, 23
    s_cbranch_scc1 L_PACE215
    s_waitcnt vmcnt(6)
L_PACE215:
    buffer_load_dwordx4 v[96:99], v2, s[8:11], s53 offen nt
    s_add_u32 s53, s53, s54
    v_and_b32_dpp v12, v40, v4 row_newbcast:8 row_mask:0xf bank_mask:0xf
    v_and_b32_dpp v13, v40, v5 row_newbcast:8 row_mask:0xf bank_mask:0xf
    v_and_b32_dpp v14, v40, v6 row_newbcast:8 row_mask:0xf bank_mask:0xf
    v_and_b32_dpp v15, v40, v7 row_newbcast:8 row_mask:0xf bank_mask:0xf
    s_waitcnt vmcnt(7)
    s_nop 0
    v_mfma_f32_16x16x32_bf16 v[8:11], v[12:15], v[108:111], v[8:11]
    v_perm_b32 v195, v92, v88, s56
    v_perm_b32 v199, v92, v88, s57
    v_perm_b32 v203, v93, v89, s56
    v_perm_b32 v207, v93, v89, s57
    v_perm_b32 v211, v94, v90, s56
    v_perm_b32 v215, v94, v90, s57
    v_perm_b32 v219, v95, v91, s56
    v_perm_b32 v223, v95, v91, s57
    buffer_load_dwordx4 v[72:75], v3, s[12:15], s59 offen offset:2048
    s_bitcmp1_b32 s17, 24
    s_cbranch_scc1 L_PACE216
    s_waitcnt vmcnt(7)
L_PACE216:
    buffer_load_dwordx4 v[100:103], v2, s[8:11], s53 offen nt
    s_add_u32 s53, s53, s54
    v_and_b32_dpp v16, v40, v4 row_newbcast:12 row_mask:0xf bank_mask:0xf
    v_and_b32_dpp v17, v40, v5 row_newbcast:12 row_mask:0xf bank_mask:0xf
    v_and_b32_dpp v18, v40, v6 row_newbcast:12 row_mask:0xf bank_mask:0xf
    v_and_b32_dpp v19, v40, v7 row_newbcast:12 row_mask:0xf bank_mask:0xf
    s_waitcnt vmcnt(8)
    s_nop 0
    v_mfma_f32_16x16x32_bf16 v[8:11], v[16:19], v[112:115], v[8:11]
    s_bitcmp1_b32 s17, 25
    s_cbranch_scc1 L_PACE217
    s_waitcnt vmcnt(6)
L_PACE217:
    buffer_load_dwordx4 v[104:107], v2, s[8:11], s53 offen nt
    s_add_u32 s53, s53, s54
    v_and_b32_dpp v12, v41, v4 row_newbcast:0 row_mask:0xf bank_mask:0xf
    v_and_b32_dpp v13, v41, v5 row_newbcast:0 row_mask:0xf bank_mask:0xf
    v_and_b32_dpp v14, v41, v6 row_newbcast:0 row_mask:0xf bank_mask:0xf
    v_and_b32_dpp v15, v41, v7 row_newbcast:0 row_mask:0xf bank_mask:0xf
    s_waitcnt vmcnt(7)
    s_nop 0
    v_mfma_f32_16x16x32_bf16 v[8:11], v[12:15], v[116:119], v[8:11]
    buffer_load_dwordx4 v[76:79], v3, s[12:15], s59 offen offset:3072
    s_bitcmp1_b32 s17, 26
    s_cbranch_scc1 L_PACE218
    s_waitcnt vmcnt(7)
L_PACE218:
    buffer_load_dwordx4 v[108:111], v2, s[8:11], s53 offen nt
    s_add_u32 s53, s53, s54
    v_and_b32_dpp v16, v41, v4 row_newbcast:4 row_mask:0xf bank_mask:0xf
    v_and_b32_dpp v17, v41, v5 row_newbcast:4 row_mask:0xf bank_mask:0xf
    v_and_b32_dpp v18, v41, v6 row_newbcast:4 row_mask:0xf bank_mask:0xf
    v_and_b32_dpp v19, v41, v7 row_newbcast:4 row_mask:0xf bank_mask:0xf
    s_waitcnt vmcnt(8)
    s_nop 0
    v_mfma_f32_16x16x32_bf16 v[8:11], v[16:19], v[120:123], v[8:11]
    s_bitcmp1_b32 s17, 27
    s_cbranch_scc1 L_PACE219
    s_waitcnt vmcnt(6)
L_PACE219:
    buffer_load_dwordx4 v[112:115], v2, s[8:11], s53 offen nt
    s_add_u32 s53, s53, s54
    v_and_b32_dpp v12, v41, v4 row_newbcast:8 row_mask:0xf bank_mask:0xf
    v_and_b32_dpp v13, v41, v5 row_newbcast:8 row_mask:0xf bank_mask:0xf
    v_and_b32_dpp v14, v41, v6 row_newbcast:8 row_mask:0xf bank_mask:0xf
    v_and_b32_dpp v15, v41, v7 row_newbcast:8 row_mask:0xf bank_mask:0xf
    s_waitcnt vmcnt(7)
    s_nop 0
    v_mfma_f32_16x16x32_bf16 v[8:11], v[12:15], v[124:127], v[8:11]
    v_perm_b32 v224, v68, v64, s56
    v_perm_b32 v228, v68, v64, s57
    v_perm_b32 v232, v69, v65, s56
    v_perm_b32 v236, v69, v65, s57
    v_perm_b32 v240, v70, v66, s56
    v_perm_b32 v244, v70, v66, s57
    v_perm_b32 v248, v71, v67, s56
    v_perm_b32 v252, v71, v67, s57
    s_add_u32 s59, s58, 102400
    buffer_load_dwordx4 v[80:83], v3, s[12:15], s59 offen offset:0
    s_bitcmp1_b32 s17, 28
    s_cbranch_scc1 L_PACE220
    s_waitcnt vmcnt(7)
L_PACE220:
    buffer_load_dwordx4 v[116:119], v2, s[8:11], s53 offen nt
    s_add_u32 s53, s53, s54
    v_and_b32_dpp v16, v41, v4 row_newbcast:12 row_mask:0xf bank_mask:0xf
    v_and_b32_dpp v17, v41, v5 row_newbcast:12 row_mask:0xf bank_mask:0xf
    v_and_b32_dpp v18, v41, v6 row_newbcast:12 row_mask:0xf bank_mask:0xf
    v_and_b32_dpp v19, v41, v7 row_newbcast:12 row_mask:0xf bank_mask:0xf
    s_waitcnt vmcnt(8)
    s_nop 0
    v_mfma_f32_16x16x32_bf16 v[8:11], v[16:19], v[96:99], v[8:11]
    s_bitcmp1_b32 s17, 29
    s_cbranch_scc1 L_PACE221
    s_waitcnt vmcnt(6)
L_PACE221:
    buffer_load_dwordx4 v[120:123], v2, s[8:11], s53 offen nt
    s_add_u32 s53, s53, s54
    v_and_b32_dpp v12, v42, v4 row_newbcast:0 row_mask:0xf bank_mask:0xf
    v_and_b32_dpp v13, v42, v5 row_newbcast:0 row_mask:0xf bank_mask:0xf
    v_and_b32_dpp v14, v42, v6 row_newbcast:0 row_mask:0xf bank_mask:0xf
    v_and_b32_dpp v15, v42, v7 row_newbcast:0 row_mask:0xf bank_mask:0xf
    s_waitcnt vmcnt(7)
    s_nop 0
    v_mfma_f32_16x16x32_bf16 v[8:11], v[12:15], v[100:103], v[8:11]
    buffer_load_dwordx4 v[84:87], v3, s[12:15], s59 offen offset:1024
    s_bitcmp1_b32 s17, 30
    s_cbranch_scc1 L_PACE222
    s_waitcnt vmcnt(7)
L_PACE222:
    buffer_load_dwordx4 v[124:127], v2, s[8:11], s53 offen nt
    s_add_u32 s53, s53, s54
    v_and_b32_dpp v16, v42, v4 row_newbcast:4 row_mask:0xf bank_mask:0xf
    v_and_b32_dpp v17, v42, v5 row_newbcast:4 row_mask:0xf bank_mask:0xf
    v_and_b32_dpp v18, v42, v6 row_newbcast:4 row_mask:0xf bank_mask:0xf
    v_and_b32_dpp v19, v42, v7 row_newbcast:4 row_mask:0xf bank_mask:0xf
    s_waitcnt vmcnt(8)
    s_nop 0
    v_mfma_f32_16x16x32_bf16 v[8:11], v[16:19], v[104:107], v[8:11]
    s_bitcmp1_b32 s17, 31
    s_cbranch_scc1 L_PACE223
    s_waitcnt vmcnt(6)
L_PACE223:
    buffer_load_dwordx4 v[96:99], v2, s[8:11], s53 offen nt
    s_add_u32 s53, s53, s54
    v_and_b32_dpp v12, v42, v4 row_newbcast:8 row_mask:0xf bank_mask:0xf
    v_and_b32_dpp v13, v42, v5 row_newbcast:8 row_mask:0xf bank_mask:0xf
    v_and_b32_dpp v14, v42, v6 row_newbcast:8 row_mask:0xf bank_mask:0xf
    v_and_b32_dpp v15, v42, v7 row_newbcast:8 row_mask:0xf bank_mask:0xf
    s_waitcnt vmcnt(7)
    s_nop 0
    v_mfma_f32_16x16x32_bf16 v[8:11], v[12:15], v[108:111], v[8:11]
    v_perm_b32 v225, v76, v72, s56
    v_perm_b32 v229, v76, v72, s57
    v_perm_b32 v233, v77, v73, s56
    v_perm_b32 v237, v77, v73, s57
    v_perm_b32 v241, v78, v74, s56
    v_perm_b32 v245, v78, v74, s57
    v_perm_b32 v249, v79, v75, s56
    v_perm_b32 v253, v79, v75, s57
    buffer_load_dwordx4 v[88:91], v3, s[12:15], s59 offen offset:2048
    s_bitcmp1_b32 s17, 0
    s_cbranch_scc1 L_PACE224
    s_waitcnt vmcnt(7)
L_PACE224:
    buffer_load_dwordx4 v[100:103], v2, s[8:11], s53 offen nt
    s_add_u32 s53, s53, s54
    v_and_b32_dpp v16, v42, v4 row_newbcast:12 row_mask:0xf bank_mask:0xf
    v_and_b32_dpp v17, v42, v5 row_newbcast:12 row_mask:0xf bank_mask:0xf
    v_and_b32_dpp v18, v42, v6 row_newbcast:12 row_mask:0xf bank_mask:0xf
    v_and_b32_dpp v19, v42, v7 row_newbcast:12 row_mask:0xf bank_mask:0xf
    s_waitcnt vmcnt(8)
    s_nop 0
    v_mfma_f32_16x16x32_bf16 v[8:11], v[16:19], v[112:115], v[8:11]
    s_bitcmp1_b32 s17, 1
    s_cbranch_scc1 L_PACE225
    s_waitcnt vmcnt(6)
L_PACE225:
    buffer_load_dwordx4 v[104:107], v2, s[8:11], s53 offen nt
    s_add_u32 s53, s53, s54
    v_and_b32_dpp v12, v43, v4 row_newbcast:0 row_mask:0xf bank_mask:0xf
    v_and_b32_dpp v13, v43, v5 row_newbcast:0 row_mask:0xf bank_mask:0xf
    v_and_b32_dpp v14, v43, v6 row_newbcast:0 row_mask:0xf bank_mask:0xf
    v_and_b32_dpp v15, v43, v7 row_newbcast:0 row_mask:0xf bank_mask:0xf
    s_waitcnt vmcnt(7)
    s_nop 0
    v_mfma_f32_16x16x32_bf16 v[8:11], v[12:15], v[116:119], v[8:11]
    buffer_load_dwordx4 v[92:95], v3, s[12:15], s59 offen offset:3072
    s_bitcmp1_b32 s17, 2
    s_cbranch_scc1 L_PACE226
    s_waitcnt vmcnt(7)
L_PACE226:
    buffer_load_dwordx4 v[108:111], v2, s[8:11], s53 offen nt
    s_add_u32 s53, s53, s54
    v_and_b32_dpp v16, v43, v4 row_newbcast:4 row_mask:0xf bank_mask:0xf
    v_and_b32_dpp v17, v43, v5 row_newbcast:4 row_mask:0xf bank_mask:0xf
    v_and_b32_dpp v18, v43, v6 row_newbcast:4 row_mask:0xf bank_mask:0xf
    v_and_b32_dpp v19, v43, v7 row_newbcast:4 row_mask:0xf bank_mask:0xf
    s_waitcnt vmcnt(8)
    s_nop 0
    v_mfma_f32_16x16x32_bf16 v[8:11], v[16:19], v[120:123], v[8:11]
    s_bitcmp1_b32 s17, 3
    s_cbranch_scc1 L_PACE227
    s_waitcnt vmcnt(6)
L_PACE227:
    buffer_load_dwordx4 v[112:115], v2, s[8:11], s53 offen nt
    s_add_u32 s53, s53, s54
    v_and_b32_dpp v12, v43, v4 row_newbcast:8 row_mask:0xf bank_mask:0xf
    v_and_b32_dpp v13, v43, v5 row_newbcast:8 row_mask:0xf bank_mask:0xf
    v_and_b32_dpp v14, v43, v6 row_newbcast:8 row_mask:0xf bank_mask:0xf
    v_and_b32_dpp v15, v43, v7 row_newbcast:8 row_mask:0xf bank_mask:0xf
    s_waitcnt vmcnt(7)
    s_nop 0
    v_mfma_f32_16x16x32_bf16 v[8:11], v[12:15], v[124:127], v[8:11]
    v_perm_b32 v226, v84, v80, s56
    v_perm_b32 v230, v84, v80, s57
    v_perm_b32 v234, v85, v81, s56
    v_perm_b32 v238, v85, v81, s57
    v_perm_b32 v242, v86, v82, s56
    v_perm_b32 v246, v86, v82, s57
    v_perm_b32 v250, v87, v83, s56
    v_perm_b32 v254, v87, v83, s57
    s_bitcmp1_b32 s17, 4
    s_cbranch_scc1 L_PACE228
    s_waitcnt vmcnt(6)
L_PACE228:
    buffer_load_dwordx4 v[116:119], v2, s[8:11], s53 offen nt
    s_add_u32 s53, s53, s54
    v_and_b32_dpp v16, v43, v4 row_newbcast:12 row_mask:0xf bank_mask:0xf
    v_and_b32_dpp v17, v43, v5 row_newbcast:12 row_mask:0xf bank_mask:0xf
    v_and_b32_dpp v18, v43, v6 row_newbcast:12 row_mask:0xf bank_mask:0xf
    v_and_b32_dpp v19, v43, v7 row_newbcast:12 row_mask:0xf bank_mask:0xf
    s_waitcnt vmcnt(7)
    s_nop 0
    v_mfma_f32_16x16x32_bf16 v[8:11], v[16:19], v[96:99], v[8:11]
    s_bitcmp1_b32 s17, 5
    s_cbranch_scc1 L_PACE229
    s_waitcnt vmcnt(5)
L_PACE229:
    buffer_load_dwordx4 v[120:123], v2, s[8:11], s53 offen nt
    s_add_u32 s53, s53, s54
    v_and_b32_dpp v12, v44, v4 row_newbcast:0 row_mask:0xf bank_mask:0xf
    v_and_b32_dpp v13, v44, v5 row_newbcast:0 row_mask:0xf bank_mask:0xf
    v_and_b32_dpp v14, v44, v6 row_newbcast:0 row_mask:0xf bank_mask:0xf
    v_and_b32_dpp v15, v44, v7 row_newbcast:0 row_mask:0xf bank_mask:0xf
    s_waitcnt vmcnt(6)
    s_nop 0
    v_mfma_f32_16x16x32_bf16 v[8:11], v[12:15], v[100:103], v[8:11]
    s_bitcmp1_b32 s17, 6
    s_cbranch_scc1 L_PACE230
    s_waitcnt vmcnt(5)
L_PACE230:
    buffer_load_dwordx4 v[124:127], v2, s[8:11], s53 offen nt
    s_add_u32 s53, s53, s54
    v_and_b32_dpp v16, v44, v4 row_newbcast:4 row_mask:0xf bank_mask:0xf
    v_and_b32_dpp v17, v44, v5 row_newbcast:4 row_mask:0xf bank_mask:0xf
    v_and_b32_dpp v18, v44, v6 row_newbcast:4 row_mask:0xf bank_mask:0xf
    v_and_b32_dpp v19, v44, v7 row_newbcast:4 row_mask:0xf bank_mask:0xf
    s_waitcnt vmcnt(6)
    s_nop 0
    v_mfma_f32_16x16x32_bf16 v[8:11], v[16:19], v[104:107], v[8:11]
    s_bitcmp1_b32 s17, 7
    s_cbranch_scc1 L_PACE231
    s_waitcnt vmcnt(4)
L_PACE231:
    buffer_load_dwordx4 v[96:99], v2, s[8:11], s53 offen nt
    s_add_u32 s53, s53, s54
    buffer_load_dwordx4 v[100:103], v2, s[8:11], s53 offen nt
    s_add_u32 s53, s53, s54
    buffer_load_dwordx4 v[104:107], v2, s[8:11], s53 offen nt
    s_add_u32 s53, s53, s54
    v_and_b32_dpp v12, v44, v4 row_newbcast:8 row_mask:0xf bank_mask:0xf
    v_and_b32_dpp v13, v44, v5 row_newbcast:8 row_mask:0xf bank_mask:0xf
    v_and_b32_dpp v14, v44, v6 row_newbcast:8 row_mask:0xf bank_mask:0xf
    v_and_b32_dpp v15, v44, v7 row_newbcast:8 row_mask:0xf bank_mask:0xf
    s_waitcnt vmcnt(7)
    s_nop 0
    v_mfma_f32_16x16x32_bf16 v[8:11], v[12:15], v[108:111], v[8:11]
    v_perm_b32 v227, v92, v88, s56
    v_perm_b32 v231, v92, v88, s57
    v_perm_b32 v235, v93, v89, s56
    v_perm_b32 v239, v93, v89, s57
    v_perm_b32 v243, v94, v90, s56
    v_perm_b32 v247, v94, v90, s57
    v_perm_b32 v251, v95, v91, s56
    v_perm_b32 v255, v95, v91, s57
    buffer_load_dwordx4 v[108:111], v2, s[8:11], s53 offen nt
    s_add_u32 s53, s53, s54
    s_bitcmp1_b32 s17, 11
    s_cbranch_scc1 L_PACE235
    s_waitcnt vmcnt(7)
L_PACE235:
    buffer_load_dwordx4 v[64:67], v2, s[8:11], s53 offen nt
    s_add_u32 s53, s53, s54
    v_and_b32_dpp v16, v44, v4 row_newbcast:12 row_mask:0xf bank_mask:0xf
    v_and_b32_dpp v17, v44, v5 row_newbcast:12 row_mask:0xf bank_mask:0xf
    v_and_b32_dpp v18, v44, v6 row_newbcast:12 row_mask:0xf bank_mask:0xf
    v_and_b32_dpp v19, v44, v7 row_newbcast:12 row_mask:0xf bank_mask:0xf
    s_waitcnt vmcnt(8)
    s_nop 0
    v_mfma_f32_16x16x32_bf16 v[8:11], v[16:19], v[112:115], v[8:11]
    s_bitcmp1_b32 s17, 12
    s_cbranch_scc1 L_PACE236
    s_waitcnt vmcnt(7)
L_PACE236:
    buffer_load_dwordx4 v[112:115], v2, s[8:11], s53 offen nt
    s_add_u32 s53, s53, s54
    v_and_b32_dpp v12, v45, v4 row_newbcast:0 row_mask:0xf bank_mask:0xf
    v_and_b32_dpp v13, v45, v5 row_newbcast:0 row_mask:0xf bank_mask:0xf
    v_and_b32_dpp v14, v45, v6 row_newbcast:0 row_mask:0xf bank_mask:0xf
    v_and_b32_dpp v15, v45, v7 row_newbcast:0 row_mask:0xf bank_mask:0xf
    s_waitcnt vmcnt(8)
    s_nop 0
    v_mfma_f32_16x16x32_bf16 v[8:11], v[12:15], v[116:119], v[8:11]
    s_bitcmp1_b32 s17, 13
    s_cbranch_scc1 L_PACE237
    s_waitcnt vmcnt(7)
L_PACE237:
    buffer_load_dwordx4 v[116:119], v2, s[8:11], s53 offen nt
    s_add_u32 s53, s53, s54
    v_and_b32_dpp v16, v45, v4 row_newbcast:4 row_mask:0xf bank_mask:0xf
    v_and_b32_dpp v17, v45, v5 row_newbcast:4 row_mask:0xf bank_mask:0xf
    v_and_b32_dpp v18, v45, v6 row_newbcast:4 row_mask:0xf bank_mask:0xf
    v_and_b32_dpp v19, v45, v7 row_newbcast:4 row_mask:0xf bank_mask:0xf
    s_waitcnt vmcnt(8)
    s_nop 0
    v_mfma_f32_16x16x32_bf16 v[8:11], v[16:19], v[120:123], v[8:11]
    s_bitcmp1_b32 s17, 14
    s_cbranch_scc1 L_PACE238
    s_waitcnt vmcnt(7)
L_PACE238:
    buffer_load_dwordx4 v[120:123], v2, s[8:11], s53 offen nt
    s_add_u32 s53, s53, s54
    v_and_b32_dpp v12, v45, v4 row_newbcast:8 row_mask:0xf bank_mask:0xf
    v_and_b32_dpp v13, v45, v5 row_newbcast:8 row_mask:0xf bank_mask:0xf
    v_and_b32_dpp v14, v45, v6 row_newbcast:8 row_mask:0xf bank_mask:0xf
    v_and_b32_dpp v15, v45, v7 row_newbcast:8 row_mask:0xf bank_mask:0xf
    s_waitcnt vmcnt(8)
    s_nop 0
    v_mfma_f32_16x16x32_bf16 v[8:11], v[12:15], v[124:127], v[8:11]
    s_bitcmp1_b32 s17, 15
    s_cbranch_scc1 L_PACE239
    s_waitcnt vmcnt(7)
L_PACE239:
    buffer_load_dwordx4 v[124:127], v2, s[8:11], s53 offen nt
    s_add_u32 s53, s53, s54
    v_and_b32_dpp v16, v45, v4 row_newbcast:12 row_mask:0xf bank_mask:0xf
    v_and_b32_dpp v17, v45, v5 row_newbcast:12 row_mask:0xf bank_mask:0xf
    v_and_b32_dpp v18, v45, v6 row_newbcast:12 row_mask:0xf bank_mask:0xf
    v_and_b32_dpp v19, v45, v7 row_newbcast:12 row_mask:0xf bank_mask:0xf
    s_waitcnt vmcnt(8)
    s_nop 0
    v_mfma_f32_16x16x32_bf16 v[8:11], v[16:19], v[96:99], v[8:11]
    s_bitcmp1_b32 s17, 16
    s_cbranch_scc1 L_PACE240
    s_waitcnt vmcnt(7)
L_PACE240:
    buffer_load_dwordx4 v[96:99], v2, s[8:11], s53 offen nt
    s_add_u32 s53, s53, s54
    v_and_b32_dpp v12, v46, v4 row_newbcast:0 row_mask:0xf bank_mask:0xf
    v_and_b32_dpp v13, v46, v5 row_newbcast:0 row_mask:0xf bank_mask:0xf
    v_and_b32_dpp v14, v46, v6 row_newbcast:0 row_mask:0xf bank_mask:0xf
    v_and_b32_dpp v15, v46, v7 row_newbcast:0 row_mask:0xf bank_mask:0xf
    s_waitcnt vmcnt(8)
    s_nop 0
    v_mfma_f32_16x16x32_bf16 v[8:11], v[12:15], v[100:103], v[8:11]
    s_bitcmp1_b32 s17, 17
    s_cbranch_scc1 L_PACE241
    s_waitcnt vmcnt(7)
L_PACE241:
    buffer_load_dwordx4 v[100:103], v2, s[8:11], s53 offen nt
    s_add_u32 s53, s53, s54
    v_and_b32_dpp v16, v46, v4 row_newbcast:4 row_mask:0xf bank_mask:0xf
    v_and_b32_dpp v17, v46, v5 row_newbcast:4 row_mask:0xf bank_mask:0xf
    v_and_b32_dpp v18, v46, v6 row_newbcast:4 row_mask:0xf bank_mask:0xf
    v_and_b32_dpp v19, v46, v7 row_newbcast:4 row_mask:0xf bank_mask:0xf
    s_waitcnt vmcnt(8)
    s_nop 0
    v_mfma_f32_16x16x32_bf16 v[8:11], v[16:19], v[104:107], v[8:11]
    s_bitcmp1_b32 s17, 18
    s_cbranch_scc1 L_PACE242
    s_waitcnt vmcnt(7)
L_PACE242:
    buffer_load_dwordx4 v[104:107], v2, s[8:11], s53 offen nt
    s_add_u32 s53, s53, s54
    v_and_b32_dpp v12, v46, v4 row_newbcast:8 row_mask:0xf bank_mask:0xf
    v_and_b32_dpp v13, v46, v5 row_newbcast:8 row_mask:0xf bank_mask:0xf
    v_and_b32_dpp v14, v46, v6 row_newbcast:8 row_mask:0xf bank_mask:0xf
    v_and_b32_dpp v15, v46, v7 row_newbcast:8 row_mask:0xf bank_mask:0xf
    s_waitcnt vmcnt(8)
    s_nop 0
    v_mfma_f32_16x16x32_bf16 v[8:11], v[12:15], v[108:111], v[8:11]
    s_bitcmp1_b32 s17, 19
    s_cbranch_scc1 L_PACE243
    s_waitcnt vmcnt(7)
L_PACE243:
    buffer_load_dwordx4 v[108:111], v2, s[8:11], s53 offen nt
    s_add_u32 s53, s53, s54
    v_and_b32_dpp v16, v46, v4 row_newbcast:12 row_mask:0xf bank_mask:0xf
    v_and_b32_dpp v17, v46, v5 row_newbcast:12 row_mask:0xf bank_mask:0xf
    v_and_b32_dpp v18, v46, v6 row_newbcast:12 row_mask:0xf bank_mask:0xf
    v_and_b32_dpp v19, v46, v7 row_newbcast:12 row_mask:0xf bank_mask:0xf
    s_waitcnt vmcnt(8)
    s_nop 0
    v_mfma_f32_16x16x32_bf16 v[8:11], v[16:19], v[64:67], v[8:11]
    s_bitcmp1_b32 s17, 20
    s_cbranch_scc1 L_PACE244
    s_waitcnt vmcnt(7)
L_PACE244:
    buffer_load_dwordx4 v[68:71], v2, s[8:11], s53 offen nt
    s_add_u32 s53, s53, s54
    v_and_b32_dpp v12, v47, v4 row_newbcast:0 row_mask:0xf bank_mask:0xf
    v_and_b32_dpp v13, v47, v5 row_newbcast:0 row_mask:0xf bank_mask:0xf
    v_and_b32_dpp v14, v47, v6 row_newbcast:0 row_mask:0xf bank_mask:0xf
    v_and_b32_dpp v15, v47, v7 row_newbcast:0 row_mask:0xf bank_mask:0xf
    s_waitcnt vmcnt(8)
    s_nop 0
    v_mfma_f32_16x16x32_bf16 v[8:11], v[12:15], v[112:115], v[8:11]
    s_bitcmp1_b32 s17, 21
    s_cbranch_scc1 L_PACE245
    s_waitcnt vmcnt(7)
L_PACE245:
    buffer_load_dwordx4 v[112:115], v2, s[8:11], s53 offen nt
    s_add_u32 s53, s53, s54
    v_and_b32_dpp v16, v47, v4 row_newbcast:4 row_mask:0xf bank_mask:0xf
    v_and_b32_dpp v17, v47, v5 row_newbcast:4 row_mask:0xf bank_mask:0xf
    v_and_b32_dpp v18, v47, v6 row_newbcast:4 row_mask:0xf bank_mask:0xf
    v_and_b32_dpp v19, v47, v7 row_newbcast:4 row_mask:0xf bank_mask:0xf
    s_waitcnt vmcnt(8)
    s_nop 0
    v_mfma_f32_16x16x32_bf16 v[8:11], v[16:19], v[116:119], v[8:11]
    s_bitcmp1_b32 s17, 22
    s_cbranch_scc1 L_PACE246
    s_waitcnt vmcnt(7)
L_PACE246:
    buffer_load_dwordx4 v[116:119], v2, s[8:11], s53 offen nt
    s_add_u32 s53, s53, s54
    v_and_b32_dpp v12, v47, v4 row_newbcast:8 row_mask:0xf bank_mask:0xf
    v_and_b32_dpp v13, v47, v5 row_newbcast:8 row_mask:0xf bank_mask:0xf
    v_and_b32_dpp v14, v47, v6 row_newbcast:8 row_mask:0xf bank_mask:0xf
    v_and_b32_dpp v15, v47, v7 row_newbcast:8 row_mask:0xf bank_mask:0xf
    s_waitcnt vmcnt(8)
    s_nop 0
    v_mfma_f32_16x16x32_bf16 v[8:11], v[12:15], v[120:123], v[8:11]
    s_bitcmp1_b32 s17, 23
    s_cbranch_scc1 L_PACE247
    s_waitcnt vmcnt(7)
L_PACE247:
    buffer_load_dwordx4 v[120:123], v2, s[8:11], s53 offen nt
    s_add_u32 s53, s53, s54
    v_and_b32_dpp v16, v47, v4 row_newbcast:12 row_mask:0xf bank_mask:0xf
    v_and_b32_dpp v17, v47, v5 row_newbcast:12 row_mask:0xf bank_mask:0xf
    v_and_b32_dpp v18, v47, v6 row_newbcast:12 row_mask:0xf bank_mask:0xf
    v_and_b32_dpp v19, v47, v7 row_newbcast:12 row_mask:0xf bank_mask:0xf
    s_waitcnt vmcnt(8)
    s_nop 0
    v_mfma_f32_16x16x32_bf16 v[8:11], v[16:19], v[124:127], v[8:11]
    s_bitcmp1_b32 s17, 24
    s_cbranch_scc1 L_PACE248
    s_waitcnt vmcnt(7)
L_PACE248:
    buffer_load_dwordx4 v[124:127], v2, s[8:11], s53 offen nt
    s_add_u32 s53, s53, s54
    v_and_b32_dpp v12, v48, v4 row_newbcast:0 row_mask:0xf bank_mask:0xf
    v_and_b32_dpp v13, v48, v5 row_newbcast:0 row_mask:0xf bank_mask:0xf
    v_and_b32_dpp v14, v48, v6 row_newbcast:0 row_mask:0xf bank_mask:0xf
    v_and_b32_dpp v15, v48, v7 row_newbcast:0 row_mask:0xf bank_mask:0xf
    s_waitcnt vmcnt(8)
    s_nop 0
    v_mfma_f32_16x16x32_bf16 v[8:11], v[12:15], v[96:99], v[8:11]
    s_bitcmp1_b32 s17, 25
    s_cbranch_scc1 L_PACE249
    s_waitcnt vmcnt(7)
L_PACE249:
    buffer_load_dwordx4 v[96:99], v2, s[8:11], s53 offen nt
    s_add_u32 s53, s53, s54
    v_and_b32_dpp v16, v48, v4 row_newbcast:4 row_mask:0xf bank_mask:0xf
    v_and_b32_dpp v17, v48, v5 row_newbcast:4 row_mask:0xf bank_mask:0xf
    v_and_b32_dpp v18, v48, v6 row_newbcast:4 row_mask:0xf bank_mask:0xf
    v_and_b32_dpp v19, v48, v7 row_newbcast:4 row_mask:0xf bank_mask:0xf
    s_waitcnt vmcnt(8)
    s_nop 0
    v_mfma_f32_16x16x32_bf16 v[8:11], v[16:19], v[100:103], v[8:11]
    s_bitcmp1_b32 s17, 26
    s_cbranch_scc1 L_PACE250
    s_waitcnt vmcnt(7)
L_PACE250:
    buffer_load_dwordx4 v[100:103], v2, s[8:11], s53 offen nt
    s_add_u32 s53, s53, s54
    v_and_b32_dpp v12, v48, v4 row_newbcast:8 row_mask:0xf bank_mask:0xf
    v_and_b32_dpp v13, v48, v5 row_newbcast:8 row_mask:0xf bank_mask:0xf
    v_and_b32_dpp v14, v48, v6 row_newbcast:8 row_mask:0xf bank_mask:0xf
    v_and_b32_dpp v15, v48, v7 row_newbcast:8 row_mask:0xf bank_mask:0xf
    s_waitcnt vmcnt(8)
    s_nop 0
    v_mfma_f32_16x16x32_bf16 v[8:11], v[12:15], v[104:107], v[8:11]
    s_bitcmp1_b32 s17, 27
    s_cbranch_scc1 L_PACE251
    s_waitcnt vmcnt(7)
L_PACE251:
    buffer_load_dwordx4 v[104:107], v2, s[8:11], s53 offen nt
    s_add_u32 s53, s53, s54
    v_and_b32_dpp v16, v48, v4 row_newbcast:12 row_mask:0xf bank_mask:0xf
    v_and_b32_dpp v17, v48, v5 row_newbcast:12 row_mask:0xf bank_mask:0xf
    v_and_b32_dpp v18, v48, v6 row_newbcast:12 row_mask:0xf bank_mask:0xf
    v_and_b32_dpp v19, v48, v7 row_newbcast:12 row_mask:0xf bank_mask:0xf
    s_waitcnt vmcnt(8)
    s_nop 0
    v_mfma_f32_16x16x32_bf16 v[8:11], v[16:19], v[108:111], v[8:11]
    s_bitcmp1_b32 s17, 28
    s_cbranch_scc1 L_PACE252
    s_waitcnt vmcnt(7)
L_PACE252:
    buffer_load_dwordx4 v[108:111], v2, s[8:11], s53 offen nt
    s_add_u32 s53, s53, s54
    v_and_b32_dpp v12, v49, v4 row_newbcast:0 row_mask:0xf bank_mask:0xf
    v_and_b32_dpp v13, v49, v5 row_newbcast:0 row_mask:0xf bank_mask:0xf
    v_and_b32_dpp v14, v49, v6 row_newbcast:0 row_mask:0xf bank_mask:0xf
    v_and_b32_dpp v15, v49, v7 row_newbcast:0 row_mask:0xf bank_mask:0xf
    s_waitcnt vmcnt(8)
    s_nop 0
    v_mfma_f32_16x16x32_bf16 v[8:11], v[12:15], v[68:71], v[8:11]
    s_bitcmp1_b32 s17, 29
    s_cbranch_scc1 L_PACE253
    s_waitcnt vmcnt(7)
L_PACE253:
    buffer_load_dwordx4 v[72:75], v2, s[8:11], s53 offen nt
    s_add_u32 s53, s53, s54
    v_and_b32_dpp v16, v49, v4 row_newbcast:4 row_mask:0xf bank_mask:0xf
    v_and_b32_dpp v17, v49, v5 row_newbcast:4 row_mask:0xf bank_mask:0xf
    v_and_b32_dpp v18, v49, v6 row_newbcast:4 row_mask:0xf bank_mask:0xf
    v_and_b32_dpp v19, v49, v7 row_newbcast:4 row_mask:0xf bank_mask:0xf
    s_waitcnt vmcnt(8)
    s_nop 0
    v_mfma_f32_16x16x32_bf16 v[8:11], v[16:19], v[112:115], v[8:11]
    s_bitcmp1_b32 s17, 30
    s_cbranch_scc1 L_PACE254
    s_waitcnt vmcnt(7)
L_PACE254:
    buffer_load_dwordx4 v[112:115], v2, s[8:11], s53 offen nt
    s_add_u32 s53, s53, s54
    v_and_b32_dpp v12, v49, v4 row_newbcast:8 row_mask:0xf bank_mask:0xf
    v_and_b32_dpp v13, v49, v5 row_newbcast:8 row_mask:0xf bank_mask:0xf
    v_and_b32_dpp v14, v49, v6 row_newbcast:8 row_mask:0xf bank_mask:0xf
    v_and_b32_dpp v15, v49, v7 row_newbcast:8 row_mask:0xf bank_mask:0xf
    s_waitcnt vmcnt(8)
    s_nop 0
    v_mfma_f32_16x16x32_bf16 v[8:11], v[12:15], v[116:119], v[8:11]
    s_bitcmp1_b32 s17, 31
    s_cbranch_scc1 L_PACE255
    s_waitcnt vmcnt(7)
L_PACE255:
    buffer_load_dwordx4 v[116:119], v2, s[8:11], s53 offen nt
    v_and_b32_dpp v16, v49, v4 row_newbcast:12 row_mask:0xf bank_mask:0xf
    v_and_b32_dpp v17, v49, v5 row_newbcast:12 row_mask:0xf bank_mask:0xf
    v_and_b32_dpp v18, v49, v6 row_newbcast:12 row_mask:0xf bank_mask:0xf
    v_and_b32_dpp v19, v49, v7 row_newbcast:12 row_mask:0xf bank_mask:0xf
    s_waitcnt vmcnt(8)
    s_nop 0
    v_mfma_f32_16x16x32_bf16 v[8:11], v[16:19], v[120:123], v[8:11]
    v_and_b32_dpp v12, v50, v4 row_newbcast:0 row_mask:0xf bank_mask:0xf
    v_and_b32_dpp v13, v50, v5 row_newbcast:0 row_mask:0xf bank_mask:0xf
    v_and_b32_dpp v14, v50, v6 row_newbcast:0 row_mask:0xf bank_mask:0xf
    v_and_b32_dpp v15, v50, v7 row_newbcast:0 row_mask:0xf bank_mask:0xf
    s_waitcnt vmcnt(7)
    s_nop 0
    v_mfma_f32_16x16x32_bf16 v[8:11], v[12:15], v[124:127], v[8:11]
    v_and_b32_dpp v16, v50, v4 row_newbcast:4 row_mask:0xf bank_mask:0xf
    v_and_b32_dpp v17, v50, v5 row_newbcast:4 row_mask:0xf bank_mask:0xf
    v_and_b32_dpp v18, v50, v6 row_newbcast:4 row_mask:0xf bank_mask:0xf
    v_and_b32_dpp v19, v50, v7 row_newbcast:4 row_mask:0xf bank_mask:0xf
    s_waitcnt vmcnt(6)
    s_nop 0
    v_mfma_f32_16x16x32_bf16 v[8:11], v[16:19], v[96:99], v[8:11]
    v_and_b32_dpp v12, v50, v4 row_newbcast:8 row_mask:0xf bank_mask:0xf
    v_and_b32_dpp v13, v50, v5 row_newbcast:8 row_mask:0xf bank_mask:0xf
    v_and_b32_dpp v14, v50, v6 row_newbcast:8 row_mask:0xf bank_mask:0xf
    v_and_b32_dpp v15, v50, v7 row_newbcast:8 row_mask:0xf bank_mask:0xf
    s_waitcnt vmcnt(5)
    s_nop 0
    v_mfma_f32_16x16x32_bf16 v[8:11], v[12:15], v[100:103], v[8:11]
    v_and_b32_dpp v16, v50, v4 row_newbcast:12 row_mask:0xf bank_mask:0xf
    v_and_b32_dpp v17, v50, v5 row_newbcast:12 row_mask:0xf bank_mask:0xf
    v_and_b32_dpp v18, v50, v6 row_newbcast:12 row_mask:0xf bank_mask:0xf
    v_and_b32_dpp v19, v50, v7 row_newbcast:12 row_mask:0xf bank_mask:0xf
    s_waitcnt vmcnt(4)
    s_nop 0
    v_mfma_f32_16x16x32_bf16 v[8:11], v[16:19], v[104:107], v[8:11]
    v_and_b32_dpp v12, v51, v4 row_newbcast:0 row_mask:0xf bank_mask:0xf
    v_and_b32_dpp v13, v51, v5 row_newbcast:0 row_mask:0xf bank_mask:0xf
    v_and_b32_dpp v14, v51, v6 row_newbcast:0 row_mask:0xf bank_mask:0xf
    v_and_b32_dpp v15, v51, v7 row_newbcast:0 row_mask:0xf bank_mask:0xf
    s_waitcnt vmcnt(3)
    s_nop 0
    v_mfma_f32_16x16x32_bf16 v[8:11], v[12:15], v[108:111], v[8:11]
    v_and_b32_dpp v16, v51, v4 row_newbcast:4 row_mask:0xf bank_mask:0xf
    v_and_b32_dpp v17, v51, v5 row_newbcast:4 row_mask:0xf bank_mask:0xf
    v_and_b32_dpp v18, v51, v6 row_newbcast:4 row_mask:0xf bank_mask:0xf
    v_and_b32_dpp v19, v51, v7 row_newbcast:4 row_mask:0xf bank_mask:0xf
    s_waitcnt vmcnt(2)
    s_nop 0
    v_mfma_f32_16x16x32_bf16 v[8:11], v[16:19], v[72:75], v[8:11]
    v_and_b32_dpp v12, v51, v4 row_newbcast:8 row_mask:0xf bank_mask:0xf
    v_and_b32_dpp v13, v51, v5 row_newbcast:8 row_mask:0xf bank_mask:0xf
    v_and_b32_dpp v14, v51, v6 row_newbcast:8 row_mask:0xf bank_mask:0xf
    v_and_b32_dpp v15, v51, v7 row_newbcast:8 row_mask:0xf bank_mask:0xf
    s_waitcnt vmcnt(1)
    s_nop 0
    v_mfma_f32_16x16x32_bf16 v[8:11], v[12:15], v[112:115], v[8:11]
    v_and_b32_dpp v16, v51, v4 row_newbcast:12 row_mask:0xf bank_mask:0xf
    v_and_b32_dpp v17, v51, v5 row_newbcast:12 row_mask:0xf bank_mask:0xf
    v_and_b32_dpp v18, v51, v6 row_newbcast:12 row_mask:0xf bank_mask:0xf
    v_and_b32_dpp v19, v51, v7 row_newbcast:12 row_mask:0xf bank_mask:0xf
    s_waitcnt vmcnt(0)
    s_nop 0
    v_mfma_f32_16x16x32_bf16 v[8:11], v[16:19], v[116:119], v[8:11]
    s_nop 7
    v_cvt_pk_bf16_f32 v52, v8, v9
    v_cvt_pk_bf16_f32 v53, v10, v11
    s_mov_b32 exec_hi, 0
    ds_write_b64 v56, v[52:53] offset:512
    s_mov_b32 exec_hi, -1
    s_waitcnt lgkmcnt(0)
    s_barrier
    ds_read_b128 v[96:99], v57 offset:512
    ds_read_b128 v[100:103], v57 offset:576
    ds_read_b128 v[104:107], v57 offset:640
    ds_read_b128 v[108:111], v57 offset:704
    ds_read_b128 v[112:115], v60 offset:320
    ds_read_b128 v[116:119], v61 offset:1536
    ds_read_b128 v[120:123], v60 offset:256
    s_waitcnt lgkmcnt(6)
    v_mfma_f32_16x16x32_bf16 v[64:67], v[96:99], v[128:131], 0
    v_mfma_f32_16x16x32_bf16 v[80:83], v[96:99], v[144:147], 0
    s_waitcnt lgkmcnt(5)
    v_mfma_f32_16x16x32_bf16 v[64:67], v[100:103], v[160:163], v[64:67]
    v_mfma_f32_16x16x32_bf16 v[80:83], v[100:103], v[176:179], v[80:83]
    s_waitcnt lgkmcnt(4)
    v_mfma_f32_16x16x32_bf16 v[64:67], v[104:107], v[192:195], v[64:67]
    v_mfma_f32_16x16x32_bf16 v[80:83], v[104:107], v[208:211], v[80:83]
    s_waitcnt lgkmcnt(3)
    v_mfma_f32_16x16x32_bf16 v[64:67], v[108:111], v[224:227], v[64:67]
    v_mfma_f32_16x16x32_bf16 v[80:83], v[108:111], v[240:243], v[80:83]
    v_mfma_f32_16x16x32_bf16 v[68:71], v[96:99], v[132:135], 0
    v_mfma_f32_16x16x32_bf16 v[84:87], v[96:99], v[148:151], 0
    v_mfma_f32_16x16x32_bf16 v[68:71], v[100:103], v[164:167], v[68:71]
    v_mfma_f32_16x16x32_bf16 v[84:87], v[100:103], v[180:183], v[84:87]
    v_mfma_f32_16x16x32_bf16 v[68:71], v[104:107], v[196:199], v[68:71]
    v_mfma_f32_16x16x32_bf16 v[84:87], v[104:107], v[212:215], v[84:87]
    v_mfma_f32_16x16x32_bf16 v[68:71], v[108:111], v[228:231], v[68:71]
    v_mfma_f32_16x16x32_bf16 v[84:87], v[108:111], v[244:247], v[84:87]
    s_waitcnt lgkmcnt(0)
    v_cndmask_b32_e64 v20, v64, v80, s[72:73]
    v_cndmask_b32_e64 v21, v65, v81, s[72:73]
    v_cndmask_b32_e64 v22, v66, v82, s[72:73]
    v_cndmask_b32_e64 v23, v67, v83, s[72:73]
    v_fmac_f32 v116, v112, v20
    v_fmac_f32 v116, v113, v21
    v_fmac_f32 v116, v114, v22
    v_fmac_f32 v116, v115, v23
    v_bfi_b32 v116, v62, v120, v116
    v_mfma_f32_16x16x32_bf16 v[72:75], v[96:99], v[136:139], 0
    v_mfma_f32_16x16x32_bf16 v[88:91], v[96:99], v[152:155], 0
    v_mfma_f32_16x16x32_bf16 v[72:75], v[100:103], v[168:171], v[72:75]
    v_mfma_f32_16x16x32_bf16 v[88:91], v[100:103], v[184:187], v[88:91]
    v_mfma_f32_16x16x32_bf16 v[72:75], v[104:107], v[200:203], v[72:75]
    v_mfma_f32_16x16x32_bf16 v[88:91], v[104:107], v[216:219], v[88:91]
    v_mfma_f32_16x16x32_bf16 v[72:75], v[108:111], v[232:235], v[72:75]
    v_mfma_f32_16x16x32_bf16 v[88:91], v[108:111], v[248:251], v[88:91]
    v_cndmask_b32_e64 v24, v68, v84, s[72:73]
    v_cndmask_b32_e64 v25, v69, v85, s[72:73]
    v_cndmask_b32_e64 v26, v70, v86, s[72:73]
    v_cndmask_b32_e64 v27, v71, v87, s[72:73]
    v_fmac_f32 v117, v112, v24
    v_fmac_f32 v117, v113, v25
    v_fmac_f32 v117, v114, v26
    v_fmac_f32 v117, v115, v27
    v_bfi_b32 v117, v62, v121, v117
    v_mfma_f32_16x16x32_bf16 v[76:79], v[96:99], v[140:143], 0
    v_mfma_f32_16x16x32_bf16 v[92:95], v[96:99], v[156:159], 0
    v_mfma_f32_16x16x32_bf16 v[76:79], v[100:103], v[172:175], v[76:79]
    v_mfma_f32_16x16x32_bf16 v[92:95], v[100:103], v[188:191], v[92:95]
    v_mfma_f32_16x16x32_bf16 v[76:79], v[104:107], v[204:207], v[76:79]
    v_mfma_f32_16x16x32_bf16 v[92:95], v[104:107], v[220:223], v[92:95]
    v_mfma_f32_16x16x32_bf16 v[76:79], v[108:111], v[236:239], v[76:79]
    v_mfma_f32_16x16x32_bf16 v[92:95], v[108:111], v[252:255], v[92:95]
    v_cndmask_b32_e64 v28, v72, v88, s[72:73]
    v_cndmask_b32_e64 v29, v73, v89, s[72:73]
    v_cndmask_b32_e64 v30, v74, v90, s[72:73]
    v_cndmask_b32_e64 v31, v75, v91, s[72:73]
    v_fmac_f32 v118, v112, v28
    v_fmac_f32 v118, v113, v29
    v_fmac_f32 v118, v114, v30
    v_fmac_f32 v118, v115, v31
    v_bfi_b32 v118, v62, v122, v118
    v_cndmask_b32_e64 v32, v76, v92, s[72:73]
    v_cndmask_b32_e64 v33, v77, v93, s[72:73]
    v_cndmask_b32_e64 v34, v78, v94, s[72:73]
    v_cndmask_b32_e64 v35, v79, v95, s[72:73]
    v_fmac_f32 v119, v112, v32
    v_fmac_f32 v119, v113, v33
    v_fmac_f32 v119, v114, v34
    v_fmac_f32 v119, v115, v35
    v_bfi_b32 v119, v62, v123, v119
    s_mov_b32 exec_hi, 0
    buffer_store_dwordx4 v[116:119], v58, s[48:51], s76 offen sc1
    s_endpgm
    s_nop 0
L_AUX:
    s_setprio 3
    s_waitcnt lgkmcnt(0)
    s_mov_b32 s12, s38
    s_and_b32 s13, s39, 0xffff
    s_mov_b32 s14, 0x100
    s_mov_b32 s15, 0x20000
    v_mov_b32 v4, 0
    s_cmp_lg_u32 s2, 0
    s_cbranch_scc1 L_NONCE_SENT
    s_memrealtime s[76:77]
    s_waitcnt lgkmcnt(0)
    s_or_b32 s77, s77, 0x80000000
    v_mov_b32 v6, s76
    v_mov_b32 v7, s77
    s_mov_b64 exec, 1
    buffer_store_dwordx2 v[6:7], v4, s[12:15], 0 offen sc1
    s_mov_b64 exec, -1
L_NONCE_SENT:
    s_mov_b32 s4, s16
    s_and_b32 s5, s17, 0xffff
    s_mov_b32 s6, 0x1000
    s_mov_b32 s7, 0x20000
    s_mov_b32 s8, s22
    s_and_b32 s9, s23, 0xffff
    s_mov_b32 s10, 0x400000
    s_mov_b32 s11, 0x20000
    v_and_b32 v1, 15, v0
    v_lshrrev_b32 v2, 4, v0
    v_and_b32 v3, 3, v0
    v_lshlrev_b32 v5, 10, v3
    v_lshl_add_u32 v5, v2, 4, v5
    s_lshl_b32 s76, s45, 7
    v_lshlrev_b32 v6, 16, v2
    v_lshl_add_u32 v6, v1, 4, v6
    s_lshl_b32 s77, s45, 19
    s_lshl_b32 s78, s44, 8
    s_add_u32 s77, s77, s78
    buffer_load_dwordx4 v[8:11], v5, s[4:7], s76 offen offset:0
    buffer_load_dwordx4 v[12:15], v5, s[4:7], s76 offen offset:64
    s_mov_b32 s56, s30
    s_and_b32 s57, s31, 0xffff
    s_mov_b32 s58, 0x1c0000
    s_mov_b32 s59, 0x20000
    s_mov_b32 s31, s77
    s_add_u32 s78, s31, 0
    buffer_load_dwordx4 v[16:19], v6, s[8:11], s78 offen nt
    s_add_u32 s78, s31, 8192
    buffer_load_dwordx4 v[20:23], v6, s[8:11], s78 offen nt
    s_add_u32 s78, s31, 16384
    buffer_load_dwordx4 v[24:27], v6, s[8:11], s78 offen nt
    s_add_u32 s78, s31, 24576
    buffer_load_dwordx4 v[28:31], v6, s[8:11], s78 offen nt
    s_add_u32 s78, s31, 32768
    buffer_load_dwordx4 v[32:35], v6, s[8:11], s78 offen nt
    s_add_u32 s78, s31, 40960
    buffer_load_dwordx4 v[36:39], v6, s[8:11], s78 offen nt
    s_add_u32 s78, s31, 49152
    buffer_load_dwordx4 v[40:43], v6, s[8:11], s78 offen nt
    s_add_u32 s78, s31, 57344
    buffer_load_dwordx4 v[44:47], v6, s[8:11], s78 offen nt
    s_add_u32 s78, s31, 262144
    buffer_load_dwordx4 v[48:51], v6, s[8:11], s78 offen nt
    s_add_u32 s78, s31, 270336
    buffer_load_dwordx4 v[52:55], v6, s[8:11], s78 offen nt
    s_add_u32 s78, s31, 278528
    buffer_load_dwordx4 v[56:59], v6, s[8:11], s78 offen nt
    s_add_u32 s78, s31, 286720
    buffer_load_dwordx4 v[60:63], v6, s[8:11], s78 offen nt
    s_add_u32 s78, s31, 294912
    buffer_load_dwordx4 v[64:67], v6, s[8:11], s78 offen nt
    s_add_u32 s78, s31, 303104
    buffer_load_dwordx4 v[68:71], v6, s[8:11], s78 offen nt
    s_add_u32 s78, s31, 311296
    buffer_load_dwordx4 v[72:75], v6, s[8:11], s78 offen nt
    s_add_u32 s78, s31, 319488
    buffer_load_dwordx4 v[76:79], v6, s[8:11], s78 offen nt
    buffer_load_dwordx2 v[252:253], v4, s[12:15], 0 offen sc1
    s_mov_b32 s48, s40
    s_and_b32 s49, s41, 0xffff
    s_mov_b32 s50, 0x20000000
    s_mov_b32 s51, 0x20000
    s_mov_b32 s52, s28
    s_and_b32 s53, s29, 0xffff
    s_mov_b32 s54, 0x1c0000
    s_mov_b32 s55, 0x20000
    s_mov_b32 s60, s32
    s_and_b32 s61, s33, 0xffff
    s_mov_b32 s62, 0x1c0000
    s_mov_b32 s63, 0x20000
    s_mov_b32 s64, s36
    s_and_b32 s65, s37, 0xffff
    s_mov_b32 s66, 0x1000
    s_mov_b32 s67, 0x20000
    s_mov_b32 s84, s34
    s_and_b32 s85, s35, 0xffff
    s_mov_b32 s86, 0x400
    s_mov_b32 s87, 0x20000
    s_mov_b32 s80, 0x5040100
    s_mov_b32 s81, 0x7060302
    s_mov_b32 s72, 0xffff0000
    s_mov_b32 s73, 0xffff0000
    s_mov_b32 s26, 0
    s_mov_b32 s27, -1
    s_lshl_b32 s28, s44, 1
    s_add_u32 s28, s28, s47
    v_lshrrev_b32 v3, 1, v2
    v_lshlrev_b32 v144, 9, v3
    v_lshl_add_u32 v144, v1, 5, v144
    v_and_b32 v3, 1, v2
    v_lshl_add_u32 v144, v3, 4, v144
    s_lshl_b32 s79, s44, 3
    s_add_u32 s79, s79, s45
    s_lshl_b32 s79, s79, 11
    v_lshrrev_b32 v3, 5, v0
    v_lshlrev_b32 v145, 11, v3
    v_and_b32 v3, 31, v0
    v_lshl_add_u32 v145, v3, 4, v145
    s_waitcnt vmcnt(9)
    v_perm_b32 v80, v20, v16, s80
    v_perm_b32 v84, v20, v16, s81
    v_perm_b32 v88, v21, v17, s80
    v_perm_b32 v92, v21, v17, s81
    v_perm_b32 v96, v22, v18, s80
    v_perm_b32 v100, v22, v18, s81
    v_perm_b32 v104, v23, v19, s80
    v_perm_b32 v108, v23, v19, s81
    v_perm_b32 v81, v28, v24, s80
    v_perm_b32 v85, v28, v24, s81
    v_perm_b32 v89, v29, v25, s80
    v_perm_b32 v93, v29, v25, s81
    v_perm_b32 v97, v30, v26, s80
    v_perm_b32 v101, v30, v26, s81
    v_perm_b32 v105, v31, v27, s80
    v_perm_b32 v109, v31, v27, s81
    v_perm_b32 v82, v36, v32, s80
    v_perm_b32 v86, v36, v32, s81
    v_perm_b32 v90, v37, v33, s80
    v_perm_b32 v94, v37, v33, s81
    v_perm_b32 v98, v38, v34, s80
    v_perm_b32 v102, v38, v34, s81
    v_perm_b32 v106, v39, v35, s80
    v_perm_b32 v110, v39, v35, s81
    v_perm_b32 v83, v44, v40, s80
    v_perm_b32 v87, v44, v40, s81
    v_perm_b32 v91, v45, v41, s80
    v_perm_b32 v95, v45, v41, s81
    v_perm_b32 v99, v46, v42, s80
    v_perm_b32 v103, v46, v42, s81
    v_perm_b32 v107, v47, v43, s80
    v_perm_b32 v111, v47, v43, s81
    v_mfma_f32_16x16x32_bf16 v[112:115], v[8:11], v[80:83], 0
    v_mfma_f32_16x16x32_bf16 v[116:119], v[8:11], v[84:87], 0
    v_mfma_f32_16x16x32_bf16 v[120:123], v[8:11], v[88:91], 0
    v_mfma_f32_16x16x32_bf16 v[124:127], v[8:11], v[92:95], 0
    v_mfma_f32_16x16x32_bf16 v[128:131], v[8:11], v[96:99], 0
    v_mfma_f32_16x16x32_bf16 v[132:135], v[8:11], v[100:103], 0
    v_mfma_f32_16x16x32_bf16 v[136:139], v[8:11], v[104:107], 0
    v_mfma_f32_16x16x32_bf16 v[140:143], v[8:11], v[108:111], 0
    s_waitcnt vmcnt(1)
    v_perm_b32 v80, v52, v48, s80
    v_perm_b32 v84, v52, v48, s81
    v_perm_b32 v88, v53, v49, s80
    v_perm_b32 v92, v53, v49, s81
    v_perm_b32 v96, v54, v50, s80
    v_perm_b32 v100, v54, v50, s81
    v_perm_b32 v104, v55, v51, s80
    v_perm_b32 v108, v55, v51, s81
    v_perm_b32 v81, v60, v56, s80
    v_perm_b32 v85, v60, v56, s81
    v_perm_b32 v89, v61, v57, s80
    v_perm_b32 v93, v61, v57, s81
    v_perm_b32 v97, v62, v58, s80
    v_perm_b32 v101, v62, v58, s81
    v_perm_b32 v105, v63, v59, s80
    v_perm_b32 v109, v63, v59, s81
    v_perm_b32 v82, v68, v64, s80
    v_perm_b32 v86, v68, v64, s81
    v_perm_b32 v90, v69, v65, s80
    v_perm_b32 v94, v69, v65, s81
    v_perm_b32 v98, v70, v66, s80
    v_perm_b32 v102, v70, v66, s81
    v_perm_b32 v106, v71, v67, s80
    v_perm_b32 v110, v71, v67, s81
    v_perm_b32 v83, v76, v72, s80
    v_perm_b32 v87, v76, v72, s81
    v_perm_b32 v91, v77, v73, s80
    v_perm_b32 v95, v77, v73, s81
    v_perm_b32 v99, v78, v74, s80
    v_perm_b32 v103, v78, v74, s81
    v_perm_b32 v107, v79, v75, s80
    v_perm_b32 v111, v79, v75, s81
    v_mfma_f32_16x16x32_bf16 v[112:115], v[12:15], v[80:83], v[112:115]
    v_mfma_f32_16x16x32_bf16 v[116:119], v[12:15], v[84:87], v[116:119]
    v_mfma_f32_16x16x32_bf16 v[120:123], v[12:15], v[88:91], v[120:123]
    v_mfma_f32_16x16x32_bf16 v[124:127], v[12:15], v[92:95], v[124:127]
    v_mfma_f32_16x16x32_bf16 v[128:131], v[12:15], v[96:99], v[128:131]
    v_mfma_f32_16x16x32_bf16 v[132:135], v[12:15], v[100:103], v[132:135]
    v_mfma_f32_16x16x32_bf16 v[136:139], v[12:15], v[104:107], v[136:139]
    v_mfma_f32_16x16x32_bf16 v[140:143], v[12:15], v[108:111], v[140:143]
    s_waitcnt vmcnt(0)
    v_cmp_eq_u32 vcc, 0, v253
    s_nop 0
    s_nop 3
    s_cbranch_vccz L_NONCE_OK
    s_mov_b32 s82, 100000
L_NONCE_SPIN:
    buffer_load_dwordx2 v[252:253], v4, s[12:15], 0 offen sc1
    s_waitcnt vmcnt(0)
    v_cmp_eq_u32 vcc, 0, v253
    s_nop 0
    s_nop 2
    s_cbranch_vccz L_NONCE_SPIN_done
    s_sleep 1
    s_sub_u32 s82, s82, 1
    s_cmp_lg_u32 s82, 0
    s_cbranch_scc1 L_NONCE_SPIN
L_NONCE_SPIN_done:
L_NONCE_OK:
    v_readfirstlane_b32 s74, v252
    v_readfirstlane_b32 s75, v253
    v_mov_b32 v254, 0x3ff
    s_mov_b32 s68, s74
    s_lshr_b32 s69, s74, 10
    s_lshr_b32 s70, s74, 20
    s_lshr_b64 s[76:77], s[74:75], 30
    s_mov_b32 s71, s76
    s_and_b32 s68, s68, 0x3ff
    s_and_b32 s69, s69, 0x3ff
    s_and_b32 s70, s70, 0x3ff
    s_and_b32 s71, s71, 0x3ff
    v_cndmask_b32_e64 v148, v112, v128, s[72:73]
    v_cndmask_b32_e64 v156, v113, v129, s[72:73]
    v_cndmask_b32_e64 v149, v116, v132, s[72:73]
    v_cndmask_b32_e64 v157, v117, v133, s[72:73]
    v_cndmask_b32_e64 v150, v120, v136, s[72:73]
    v_cndmask_b32_e64 v158, v121, v137, s[72:73]
    v_cndmask_b32_e64 v151, v124, v140, s[72:73]
    v_cndmask_b32_e64 v159, v125, v141, s[72:73]
    v_cndmask_b32_e64 v148, v148, v156, s[26:27]
    v_cndmask_b32_e64 v149, v149, v157, s[26:27]
    v_cndmask_b32_e64 v150, v150, v158, s[26:27]
    v_cndmask_b32_e64 v151, v151, v159, s[26:27]
    v_bfi_b32 v148, v254, s68, v148
    v_bfi_b32 v149, v254, s69, v149
    v_bfi_b32 v150, v254, s70, v150
    v_bfi_b32 v151, v254, s71, v151
    buffer_store_dwordx4 v[148:151], v144, s[48:51], s79 offen offset:0 sc1
    v_cndmask_b32_e64 v152, v114, v130, s[72:73]
    v_cndmask_b32_e64 v156, v115, v131, s[72:73]
    v_cndmask_b32_e64 v153, v118, v134, s[72:73]
    v_cndmask_b32_e64 v157, v119, v135, s[72:73]
    v_cndmask_b32_e64 v154, v122, v138, s[72:73]
    v_cndmask_b32_e64 v158, v123, v139, s[72:73]
    v_cndmask_b32_e64 v155, v126, v142, s[72:73]
    v_cndmask_b32_e64 v159, v127, v143, s[72:73]
    v_cndmask_b32_e64 v152, v152, v156, s[26:27]
    v_cndmask_b32_e64 v153, v153, v157, s[26:27]
    v_cndmask_b32_e64 v154, v154, v158, s[26:27]
    v_cndmask_b32_e64 v155, v155, v159, s[26:27]
    v_bfi_b32 v152, v254, s68, v152
    v_bfi_b32 v153, v254, s69, v153
    v_bfi_b32 v154, v254, s70, v154
    v_bfi_b32 v155, v254, s71, v155
    buffer_store_dwordx4 v[152:155], v144, s[48:51], s79 offen offset:1024 sc1
    s_lshl_b32 s76, s44, 14
    s_lshl_b32 s77, s46, 9
    s_add_u32 s76, s76, s77
    s_mov_b32 s82, 100000
L_QSPIN:
    s_sleep 24
    s_add_u32 s77, s76, 0
    buffer_load_dwordx4 v[16:19], v145, s[48:51], s77 offen sc1
    s_add_u32 s77, s76, 4096
    buffer_load_dwordx4 v[20:23], v145, s[48:51], s77 offen sc1
    s_add_u32 s77, s76, 8192
    buffer_load_dwordx4 v[24:27], v145, s[48:51], s77 offen sc1
    s_add_u32 s77, s76, 12288
    buffer_load_dwordx4 v[28:31], v145, s[48:51], s77 offen sc1
    s_waitcnt vmcnt(0)
    v_xor_b32 v16, s68, v16
    v_xor_b32 v17, s69, v17
    v_xor_b32 v18, s70, v18
    v_xor_b32 v19, s71, v19
    v_or_b32 v146, v16, v17
    v_or3_b32 v146, v146, v18, v19
    v_xor_b32 v20, s68, v20
    v_xor_b32 v21, s69, v21
    v_xor_b32 v22, s70, v22
    v_xor_b32 v23, s71, v23
    v_or3_b32 v146, v146, v20, v21
    v_or3_b32 v146, v146, v22, v23
    v_xor_b32 v24, s68, v24
    v_xor_b32 v25, s69, v25
    v_xor_b32 v26, s70, v26
    v_xor_b32 v27, s71, v27
    v_or3_b32 v146, v146, v24, v25
    v_or3_b32 v146, v146, v26, v27
    v_xor_b32 v28, s68, v28
    v_xor_b32 v29, s69, v29
    v_xor_b32 v30, s70, v30
    v_xor_b32 v31, s71, v31
    v_or3_b32 v146, v146, v28, v29
    v_or3_b32 v146, v146, v30, v31
    v_and_b32 v146, 0x3ff, v146
    v_cmp_ne_u32 vcc, 0, v146
    s_nop 0
    s_nop 2
    s_cbranch_vccz L_QSPIN_done
    s_sub_u32 s82, s82, 1
    s_cmp_lg_u32 s82, 0
    s_cbranch_scc1 L_QSPIN
L_QSPIN_done:
    v_add_f32 v16, v16, v20
    v_add_f32 v17, v17, v21
    v_add_f32 v18, v18, v22
    v_add_f32 v19, v19, v23
    v_add_f32 v16, v16, v24
    v_add_f32 v17, v17, v25
    v_add_f32 v18, v18, v26
    v_add_f32 v19, v19, v27
    v_add_f32 v16, v16, v28
    v_add_f32 v17, v17, v29
    v_add_f32 v18, v18, v30
    v_add_f32 v19, v19, v31
    v_mov_b32 v20, v16
    v_mov_b32 v21, v17
    v_mov_b32 v22, v18
    v_mov_b32 v23, v19
    v_permlane32_swap_b32 v16, v20
    v_permlane32_swap_b32 v17, v21
    v_permlane32_swap_b32 v18, v22
    v_permlane32_swap_b32 v19, v23
    v_add_f32 v16, v16, v20
    v_add_f32 v17, v17, v21
    v_add_f32 v18, v18, v22
    v_add_f32 v19, v19, v23
    v_cvt_pk_bf16_f32 v16, v16, v17
    v_cvt_pk_bf16_f32 v17, v18, v19
    v_and_b32 v147, 31, v0
    v_lshlrev_b32 v147, 3, v147
    s_mov_b32 exec_hi, 0
    ds_write_b64 v147, v[16:17] offset:0
    s_mov_b64 exec, 1
    v_mov_b32 v20, s68
    v_mov_b32 v21, s69
    v_mov_b32 v22, s70
    v_mov_b32 v23, s71
    ds_write_b128 v4, v[20:23] offset:256
    ds_write_b32 v4, v4 offset:272
    ds_write_b32 v4, v4 offset:276
    s_mov_b64 exec, -1
    s_waitcnt lgkmcnt(0)
    s_barrier
    s_setprio 0
    v_lshlrev_b32 v5, 4, v0
    s_lshl_b32 s76, s46, 10
    buffer_load_dwordx4 v[8:11], v5, s[4:7], s76 offen
    buffer_load_dwordx4 v[12:15], v5, s[84:87], 0 offen
    s_waitcnt vmcnt(0)
    v_mov_b32 v250, 0
    v_lshlrev_b32 v16, 16, v8
    v_lshlrev_b32 v17, 16, v12
    v_fmac_f32 v250, v16, v17
    v_and_b32 v16, 0xffff0000, v8
    v_and_b32 v17, 0xffff0000, v12
    v_fmac_f32 v250, v16, v17
    v_lshlrev_b32 v16, 16, v9
    v_lshlrev_b32 v17, 16, v13
    v_fmac_f32 v250, v16, v17
    v_and_b32 v16, 0xffff0000, v9
    v_and_b32 v17, 0xffff0000, v13
    v_fmac_f32 v250, v16, v17
    v_lshlrev_b32 v16, 16, v10
    v_lshlrev_b32 v17, 16, v14
    v_fmac_f32 v250, v16, v17
    v_and_b32 v16, 0xffff0000, v10
    v_and_b32 v17, 0xffff0000, v14
    v_fmac_f32 v250, v16, v17
    v_lshlrev_b32 v16, 16, v11
    v_lshlrev_b32 v17, 16, v15
    v_fmac_f32 v250, v16, v17
    v_and_b32 v16, 0xffff0000, v11
    v_and_b32 v17, 0xffff0000, v15
    v_fmac_f32 v250, v16, v17
    s_nop 1
    v_add_f32_dpp v250, v250, v250 row_ror:1 row_mask:0xf bank_mask:0xf
    s_nop 1
    v_add_f32_dpp v250, v250, v250 row_ror:2 row_mask:0xf bank_mask:0xf
    s_nop 1
    v_add_f32_dpp v250, v250, v250 row_ror:4 row_mask:0xf bank_mask:0xf
    s_nop 1
    v_add_f32_dpp v250, v250, v250 row_ror:8 row_mask:0xf bank_mask:0xf
    v_mov_b32 v16, v250
    s_nop 1
    v_permlane16_swap_b32 v250, v16
    v_add_f32 v250, v250, v16
    v_mov_b32 v16, v250
    s_nop 1
    v_permlane32_swap_b32 v250, v16
    v_add_f32 v250, v250, v16
    v_mul_f32 v250, 0xbfb8aa3b, v250
    v_exp_f32 v250, v250
    s_nop 0
    v_add_f32 v250, 1.0, v250
    v_rcp_f32 v250, v250
    s_nop 0
    v_sub_f32 v251, 1.0, v250
    s_lshr_b32 s76, s2, 3
    s_mov_b32 s77, 0x7f
    s_bitcmp1_b32 s77, s76
    s_cbranch_scc0 L_NO_FFNA
    s_lshl_b32 s76, 1, s76
    s_sub_u32 s76, s76, 1
    s_and_b32 s76, s76, s77
    s_bcnt1_i32_b32 s76, s76
    s_mul_i32 s83, s42, 7
    s_add_u32 s83, s83, s76
    v_lshlrev_b32 v5, 4, v0
    buffer_load_dwordx4 v[8:11], v5, s[4:7], 0 offen offset:0
    buffer_load_dwordx4 v[12:15], v5, s[4:7], 0 offen offset:1024
    buffer_load_dwordx4 v[16:19], v5, s[4:7], 0 offen offset:2048
    buffer_load_dwordx4 v[20:23], v5, s[4:7], 0 offen offset:3072
    v_lshrrev_b32 v3, 2, v1
    v_lshl_add_u32 v3, v3, 2, v2
    s_movk_i32 s76, 3584
    v_mul_lo_u32 v6, v3, s76
    v_lshlrev_b32 v184, 1, v3
    v_and_b32 v3, 3, v1
    v_lshl_add_u32 v6, v3, 4, v6
    v_lshl_add_u32 v184, v3, 10, v184
    s_lshl_b32 s79, s83, 6
    s_waitcnt vmcnt(0)
    ds_write_b128 v5, v[8:11] offset:3584
    ds_write_b128 v5, v[12:15] offset:4608
    ds_write_b128 v5, v[16:19] offset:5632
    ds_write_b128 v5, v[20:23] offset:6656
    s_waitcnt lgkmcnt(0)
    ds_read_u16 v24, v184 offset:3584
    ds_read_u16 v25, v184 offset:3616
    ds_read_u16 v26, v184 offset:3648
    ds_read_u16 v27, v184 offset:3680
    ds_read_u16 v28, v184 offset:3712
    ds_read_u16 v29, v184 offset:3744
    ds_read_u16 v30, v184 offset:3776
    ds_read_u16 v31, v184 offset:3808
    s_waitcnt lgkmcnt(0)
    v_lshl_or_b32 v8, v25, 16, v24
    v_lshl_or_b32 v9, v27, 16, v26
    v_lshl_or_b32 v10, v29, 16, v28
    v_lshl_or_b32 v11, v31, 16, v30
    ds_read_u16 v24, v184 offset:3840
    ds_read_u16 v25, v184 offset:3872
    ds_read_u16 v26, v184 offset:3904
    ds_read_u16 v27, v184 offset:3936
    ds_read_u16 v28, v184 offset:3968
    ds_read_u16 v29, v184 offset:4000
    ds_read_u16 v30, v184 offset:4032
    ds_read_u16 v31, v184 offset:4064
    s_waitcnt lgkmcnt(0)
    v_lshl_or_b32 v12, v25, 16, v24
    v_lshl_or_b32 v13, v27, 16, v26
    v_lshl_or_b32 v14, v29, 16, v28
    v_lshl_or_b32 v15, v31, 16, v30
    ds_read_u16 v24, v184 offset:4096
    ds_read_u16 v25, v184 offset:4128
    ds_read_u16 v26, v184 offset:4160
    ds_read_u16 v27, v184 offset:4192
    ds_read_u16 v28, v184 offset:4224
    ds_read_u16 v29, v184 offset:4256
    ds_read_u16 v30, v184 offset:4288
    ds_read_u16 v31, v184 offset:4320
    s_waitcnt lgkmcnt(0)
    v_lshl_or_b32 v16, v25, 16, v24
    v_lshl_or_b32 v17, v27, 16, v26
    v_lshl_or_b32 v18, v29, 16, v28
    v_lshl_or_b32 v19, v31, 16, v30
    ds_read_u16 v24, v184 offset:4352
    ds_read_u16 v25, v184 offset:4384
    ds_read_u16 v26, v184 offset:4416
    ds_read_u16 v27, v184 offset:4448
    ds_read_u16 v28, v184 offset:4480
    ds_read_u16 v29, v184 offset:4512
    ds_read_u16 v30, v184 offset:4544
    ds_read_u16 v31, v184 offset:4576
    s_waitcnt lgkmcnt(0)
    v_lshl_or_b32 v20, v25, 16, v24
    v_lshl_or_b32 v21, v27, 16, v26
    v_lshl_or_b32 v22, v29, 16, v28
    v_lshl_or_b32 v23, v31, 16, v30
    s_add_u32 s78, s79, 0
    buffer_load_dwordx4 v[24:27], v6, s[52:55], s78 offen nt
    s_add_u32 s78, s79, 57344
    buffer_load_dwordx4 v[28:31], v6, s[52:55], s78 offen nt
    s_add_u32 s78, s79, 114688
    buffer_load_dwordx4 v[32:35], v6, s[52:55], s78 offen nt
    s_add_u32 s78, s79, 172032
    buffer_load_dwordx4 v[36:39], v6, s[52:55], s78 offen nt
    s_waitcnt vmcnt(3)
    s_add_u32 s78, s79, 229376
    buffer_load_dwordx4 v[40:43], v6, s[52:55], s78 offen nt
    s_waitcnt vmcnt(3)
    s_add_u32 s78, s79, 286720
    buffer_load_dwordx4 v[44:47], v6, s[52:55], s78 offen nt
    s_waitcnt vmcnt(3)
    s_add_u32 s78, s79, 344064
    buffer_load_dwordx4 v[48:51], v6, s[52:55], s78 offen nt
    s_waitcnt vmcnt(3)
    s_add_u32 s78, s79, 401408
    buffer_load_dwordx4 v[52:55], v6, s[52:55], s78 offen nt
    s_waitcnt vmcnt(3)
    s_add_u32 s78, s79, 0
    buffer_load_dwordx4 v[56:59], v6, s[56:59], s78 offen nt
    s_waitcnt vmcnt(3)
    s_add_u32 s78, s79, 57344
    buffer_load_dwordx4 v[60:63], v6, s[56:59], s78 offen nt
    s_waitcnt vmcnt(3)
    s_add_u32 s78, s79, 114688
    buffer_load_dwordx4 v[64:67], v6, s[56:59], s78 offen nt
    s_waitcnt vmcnt(3)
    s_add_u32 s78, s79, 172032
    buffer_load_dwordx4 v[68:71], v6, s[56:59], s78 offen nt
    v_perm_b32 v88, v28, v24, s80
    v_perm_b32 v92, v28, v24, s81
    v_perm_b32 v96, v29, v25, s80
    v_perm_b32 v100, v29, v25, s81
    v_perm_b32 v104, v30, v26, s80
    v_perm_b32 v108, v30, v26, s81
    v_perm_b32 v112, v31, v27, s80
    v_perm_b32 v116, v31, v27, s81
    v_perm_b32 v89, v36, v32, s80
    v_perm_b32 v93, v36, v32, s81
    v_perm_b32 v97, v37, v33, s80
    v_perm_b32 v101, v37, v33, s81
    v_perm_b32 v105, v38, v34, s80
    v_perm_b32 v109, v38, v34, s81
    v_perm_b32 v113, v39, v35, s80
    v_perm_b32 v117, v39, v35, s81
    v_perm_b32 v90, v44, v40, s80
    v_perm_b32 v94, v44, v40, s81
    v_perm_b32 v98, v45, v41, s80
    v_perm_b32 v102, v45, v41, s81
    v_perm_b32 v106, v46, v42, s80
    v_perm_b32 v110, v46, v42, s81
    v_perm_b32 v114, v47, v43, s80
    v_perm_b32 v118, v47, v43, s81
    v_perm_b32 v91, v52, v48, s80
    v_perm_b32 v95, v52, v48, s81
    v_perm_b32 v99, v53, v49, s80
    v_perm_b32 v103, v53, v49, s81
    v_perm_b32 v107, v54, v50, s80
    v_perm_b32 v111, v54, v50, s81
    v_perm_b32 v115, v55, v51, s80
    v_perm_b32 v119, v55, v51, s81
    v_mfma_f32_16x16x32_bf16 v[120:123], v[8:11], v[88:91], 0
    v_mfma_f32_16x16x32_bf16 v[124:127], v[8:11], v[92:95], 0
    v_mfma_f32_16x16x32_bf16 v[128:131], v[8:11], v[96:99], 0
    v_mfma_f32_16x16x32_bf16 v[132:135], v[8:11], v[100:103], 0
    v_mfma_f32_16x16x32_bf16 v[136:139], v[8:11], v[104:107], 0
    v_mfma_f32_16x16x32_bf16 v[140:143], v[8:11], v[108:111], 0
    v_mfma_f32_16x16x32_bf16 v[144:147], v[8:11], v[112:115], 0
    v_mfma_f32_16x16x32_bf16 v[148:151], v[8:11], v[116:119], 0
    s_waitcnt vmcnt(3)
    s_add_u32 s78, s79, 229376
    buffer_load_dwordx4 v[72:75], v6, s[56:59], s78 offen nt
    s_waitcnt vmcnt(3)
    s_add_u32 s78, s79, 286720
    buffer_load_dwordx4 v[76:79], v6, s[56:59], s78 offen nt
    s_waitcnt vmcnt(3)
    s_add_u32 s78, s79, 344064
    buffer_load_dwordx4 v[80:83], v6, s[56:59], s78 offen nt
    s_waitcnt vmcnt(3)
    s_add_u32 s78, s79, 401408
    buffer_load_dwordx4 v[84:87], v6, s[56:59], s78 offen nt
    s_waitcnt vmcnt(3)
    s_add_u32 s78, s79, 458752
    buffer_load_dwordx4 v[24:27], v6, s[52:55], s78 offen nt
    s_waitcnt vmcnt(3)
    s_add_u32 s78, s79, 516096
    buffer_load_dwordx4 v[28:31], v6, s[52:55], s78 offen nt
    s_waitcnt vmcnt(3)
    s_add_u32 s78, s79, 573440
    buffer_load_dwordx4 v[32:35], v6, s[52:55], s78 offen nt
    s_waitcnt vmcnt(3)
    s_add_u32 s78, s79, 630784
    buffer_load_dwordx4 v[36:39], v6, s[52:55], s78 offen nt
    v_perm_b32 v88, v60, v56, s80
    v_perm_b32 v92, v60, v56, s81
    v_perm_b32 v96, v61, v57, s80
    v_perm_b32 v100, v61, v57, s81
    v_perm_b32 v104, v62, v58, s80
    v_perm_b32 v108, v62, v58, s81
    v_perm_b32 v112, v63, v59, s80
    v_perm_b32 v116, v63, v59, s81
    v_perm_b32 v89, v68, v64, s80
    v_perm_b32 v93, v68, v64, s81
    v_perm_b32 v97, v69, v65, s80
    v_perm_b32 v101, v69, v65, s81
    v_perm_b32 v105, v70, v66, s80
    v_perm_b32 v109, v70, v66, s81
    v_perm_b32 v113, v71, v67, s80
    v_perm_b32 v117, v71, v67, s81
    v_perm_b32 v90, v76, v72, s80
    v_perm_b32 v94, v76, v72, s81
    v_perm_b32 v98, v77, v73, s80
    v_perm_b32 v102, v77, v73, s81
    v_perm_b32 v106, v78, v74, s80
    v_perm_b32 v110, v78, v74, s81
    v_perm_b32 v114, v79, v75, s80
    v_perm_b32 v118, v79, v75, s81
    v_perm_b32 v91, v84, v80, s80
    v_perm_b32 v95, v84, v80, s81
    v_perm_b32 v99, v85, v81, s80
    v_perm_b32 v103, v85, v81, s81
    v_perm_b32 v107, v86, v82, s80
    v_perm_b32 v111, v86, v82, s81
    v_perm_b32 v115, v87, v83, s80
    v_perm_b32 v119, v87, v83, s81
    v_mfma_f32_16x16x32_bf16 v[152:155], v[8:11], v[88:91], 0
    v_mfma_f32_16x16x32_bf16 v[156:159], v[8:11], v[92:95], 0
    v_mfma_f32_16x16x32_bf16 v[160:163], v[8:11], v[96:99], 0
    v_mfma_f32_16x16x32_bf16 v[164:167], v[8:11], v[100:103], 0
    v_mfma_f32_16x16x32_bf16 v[168:171], v[8:11], v[104:107], 0
    v_mfma_f32_16x16x32_bf16 v[172:175], v[8:11], v[108:111], 0
    v_mfma_f32_16x16x32_bf16 v[176:179], v[8:11], v[112:115], 0
    v_mfma_f32_16x16x32_bf16 v[180:183], v[8:11], v[116:119], 0
    s_waitcnt vmcnt(3)
    s_add_u32 s78, s79, 688128
    buffer_load_dwordx4 v[40:43], v6, s[52:55], s78 offen nt
    s_waitcnt vmcnt(3)
    s_add_u32 s78, s79, 745472
    buffer_load_dwordx4 v[44:47], v6, s[52:55], s78 offen nt
    s_waitcnt vmcnt(3)
    s_add_u32 s78, s79, 802816
    buffer_load_dwordx4 v[48:51], v6, s[52:55], s78 offen nt
    s_waitcnt vmcnt(3)
    s_add_u32 s78, s79, 860160
    buffer_load_dwordx4 v[52:55], v6, s[52:55], s78 offen nt
    s_waitcnt vmcnt(3)
    s_add_u32 s78, s79, 458752
    buffer_load_dwordx4 v[56:59], v6, s[56:59], s78 offen nt
    s_waitcnt vmcnt(3)
    s_add_u32 s78, s79, 516096
    buffer_load_dwordx4 v[60:63], v6, s[56:59], s78 offen nt
    s_waitcnt vmcnt(3)
    s_add_u32 s78, s79, 573440
    buffer_load_dwordx4 v[64:67], v6, s[56:59], s78 offen nt
    s_waitcnt vmcnt(3)
    s_add_u32 s78, s79, 630784
    buffer_load_dwordx4 v[68:71], v6, s[56:59], s78 offen nt
    v_perm_b32 v88, v28, v24, s80
    v_perm_b32 v92, v28, v24, s81
    v_perm_b32 v96, v29, v25, s80
    v_perm_b32 v100, v29, v25, s81
    v_perm_b32 v104, v30, v26, s80
    v_perm_b32 v108, v30, v26, s81
    v_perm_b32 v112, v31, v27, s80
    v_perm_b32 v116, v31, v27, s81
    v_perm_b32 v89, v36, v32, s80
    v_perm_b32 v93, v36, v32, s81
    v_perm_b32 v97, v37, v33, s80
    v_perm_b32 v101, v37, v33, s81
    v_perm_b32 v105, v38, v34, s80
    v_perm_b32 v109, v38, v34, s81
    v_perm_b32 v113, v39, v35, s80
    v_perm_b32 v117, v39, v35, s81
    v_perm_b32 v90, v44, v40, s80
    v_perm_b32 v94, v44, v40, s81
    v_perm_b32 v98, v45, v41, s80
    v_perm_b32 v102, v45, v41, s81
    v_perm_b32 v106, v46, v42, s80
    v_perm_b32 v110, v46, v42, s81
    v_perm_b32 v114, v47, v43, s80
    v_perm_b32 v118, v47, v43, s81
    v_perm_b32 v91, v52, v48, s80
    v_perm_b32 v95, v52, v48, s81
    v_perm_b32 v99, v53, v49, s80
    v_perm_b32 v103, v53, v49, s81
    v_perm_b32 v107, v54, v50, s80
    v_perm_b32 v111, v54, v50, s81
    v_perm_b32 v115, v55, v51, s80
    v_perm_b32 v119, v55, v51, s81
    v_mfma_f32_16x16x32_bf16 v[120:123], v[12:15], v[88:91], v[120:123]
    v_mfma_f32_16x16x32_bf16 v[124:127], v[12:15], v[92:95], v[124:127]
    v_mfma_f32_16x16x32_bf16 v[128:131], v[12:15], v[96:99], v[128:131]
    v_mfma_f32_16x16x32_bf16 v[132:135], v[12:15], v[100:103], v[132:135]
    v_mfma_f32_16x16x32_bf16 v[136:139], v[12:15], v[104:107], v[136:139]
    v_mfma_f32_16x16x32_bf16 v[140:143], v[12:15], v[108:111], v[140:143]
    v_mfma_f32_16x16x32_bf16 v[144:147], v[12:15], v[112:115], v[144:147]
    v_mfma_f32_16x16x32_bf16 v[148:151], v[12:15], v[116:119], v[148:151]
    s_waitcnt vmcnt(3)
    s_add_u32 s78, s79, 688128
    buffer_load_dwordx4 v[72:75], v6, s[56:59], s78 offen nt
    s_waitcnt vmcnt(3)
    s_add_u32 s78, s79, 745472
    buffer_load_dwordx4 v[76:79], v6, s[56:59], s78 offen nt
    s_waitcnt vmcnt(3)
    s_add_u32 s78, s79, 802816
    buffer_load_dwordx4 v[80:83], v6, s[56:59], s78 offen nt
    s_waitcnt vmcnt(3)
    s_add_u32 s78, s79, 860160
    buffer_load_dwordx4 v[84:87], v6, s[56:59], s78 offen nt
    s_waitcnt vmcnt(3)
    s_add_u32 s78, s79, 917504
    buffer_load_dwordx4 v[24:27], v6, s[52:55], s78 offen nt
    s_waitcnt vmcnt(3)
    s_add_u32 s78, s79, 974848
    buffer_load_dwordx4 v[28:31], v6, s[52:55], s78 offen nt
    s_waitcnt vmcnt(3)
    s_add_u32 s78, s79, 1032192
    buffer_load_dwordx4 v[32:35], v6, s[52:55], s78 offen nt
    s_waitcnt vmcnt(3)
    s_add_u32 s78, s79, 1089536
    buffer_load_dwordx4 v[36:39], v6, s[52:55], s78 offen nt
    v_perm_b32 v88, v60, v56, s80
    v_perm_b32 v92, v60, v56, s81
    v_perm_b32 v96, v61, v57, s80
    v_perm_b32 v100, v61, v57, s81
    v_perm_b32 v104, v62, v58, s80
    v_perm_b32 v108, v62, v58, s81
    v_perm_b32 v112, v63, v59, s80
    v_perm_b32 v116, v63, v59, s81
    v_perm_b32 v89, v68, v64, s80
    v_perm_b32 v93, v68, v64, s81
    v_perm_b32 v97, v69, v65, s80
    v_perm_b32 v101, v69, v65, s81
    v_perm_b32 v105, v70, v66, s80
    v_perm_b32 v109, v70, v66, s81
    v_perm_b32 v113, v71, v67, s80
    v_perm_b32 v117, v71, v67, s81
    v_perm_b32 v90, v76, v72, s80
    v_perm_b32 v94, v76, v72, s81
    v_perm_b32 v98, v77, v73, s80
    v_perm_b32 v102, v77, v73, s81
    v_perm_b32 v106, v78, v74, s80
    v_perm_b32 v110, v78, v74, s81
    v_perm_b32 v114, v79, v75, s80
    v_perm_b32 v118, v79, v75, s81
    v_perm_b32 v91, v84, v80, s80
    v_perm_b32 v95, v84, v80, s81
    v_perm_b32 v99, v85, v81, s80
    v_perm_b32 v103, v85, v81, s81
    v_perm_b32 v107, v86, v82, s80
    v_perm_b32 v111, v86, v82, s81
    v_perm_b32 v115, v87, v83, s80
    v_perm_b32 v119, v87, v83, s81
    v_mfma_f32_16x16x32_bf16 v[152:155], v[12:15], v[88:91], v[152:155]
    v_mfma_f32_16x16x32_bf16 v[156:159], v[12:15], v[92:95], v[156:159]
    v_mfma_f32_16x16x32_bf16 v[160:163], v[12:15], v[96:99], v[160:163]
    v_mfma_f32_16x16x32_bf16 v[164:167], v[12:15], v[100:103], v[164:167]
    v_mfma_f32_16x16x32_bf16 v[168:171], v[12:15], v[104:107], v[168:171]
    v_mfma_f32_16x16x32_bf16 v[172:175], v[12:15], v[108:111], v[172:175]
    v_mfma_f32_16x16x32_bf16 v[176:179], v[12:15], v[112:115], v[176:179]
    v_mfma_f32_16x16x32_bf16 v[180:183], v[12:15], v[116:119], v[180:183]
    s_waitcnt vmcnt(3)
    s_add_u32 s78, s79, 1146880
    buffer_load_dwordx4 v[40:43], v6, s[52:55], s78 offen nt
    s_waitcnt vmcnt(3)
    s_add_u32 s78, s79, 1204224
    buffer_load_dwordx4 v[44:47], v6, s[52:55], s78 offen nt
    s_waitcnt vmcnt(3)
    s_add_u32 s78, s79, 1261568
    buffer_load_dwordx4 v[48:51], v6, s[52:55], s78 offen nt
    s_waitcnt vmcnt(3)
    s_add_u32 s78, s79, 1318912
    buffer_load_dwordx4 v[52:55], v6, s[52:55], s78 offen nt
    s_waitcnt vmcnt(3)
    s_add_u32 s78, s79, 917504
    buffer_load_dwordx4 v[56:59], v6, s[56:59], s78 offen nt
    s_waitcnt vmcnt(3)
    s_add_u32 s78, s79, 974848
    buffer_load_dwordx4 v[60:63], v6, s[56:59], s78 offen nt
    s_waitcnt vmcnt(3)
    s_add_u32 s78, s79, 1032192
    buffer_load_dwordx4 v[64:67], v6, s[56:59], s78 offen nt
    s_waitcnt vmcnt(3)
    s_add_u32 s78, s79, 1089536
    buffer_load_dwordx4 v[68:71], v6, s[56:59], s78 offen nt
    v_perm_b32 v88, v28, v24, s80
    v_perm_b32 v92, v28, v24, s81
    v_perm_b32 v96, v29, v25, s80
    v_perm_b32 v100, v29, v25, s81
    v_perm_b32 v104, v30, v26, s80
    v_perm_b32 v108, v30, v26, s81
    v_perm_b32 v112, v31, v27, s80
    v_perm_b32 v116, v31, v27, s81
    v_perm_b32 v89, v36, v32, s80
    v_perm_b32 v93, v36, v32, s81
    v_perm_b32 v97, v37, v33, s80
    v_perm_b32 v101, v37, v33, s81
    v_perm_b32 v105, v38, v34, s80
    v_perm_b32 v109, v38, v34, s81
    v_perm_b32 v113, v39, v35, s80
    v_perm_b32 v117, v39, v35, s81
    v_perm_b32 v90, v44, v40, s80
    v_perm_b32 v94, v44, v40, s81
    v_perm_b32 v98, v45, v41, s80
    v_perm_b32 v102, v45, v41, s81
    v_perm_b32 v106, v46, v42, s80
    v_perm_b32 v110, v46, v42, s81
    v_perm_b32 v114, v47, v43, s80
    v_perm_b32 v118, v47, v43, s81
    v_perm_b32 v91, v52, v48, s80
    v_perm_b32 v95, v52, v48, s81
    v_perm_b32 v99, v53, v49, s80
    v_perm_b32 v103, v53, v49, s81
    v_perm_b32 v107, v54, v50, s80
    v_perm_b32 v111, v54, v50, s81
    v_perm_b32 v115, v55, v51, s80
    v_perm_b32 v119, v55, v51, s81
    v_mfma_f32_16x16x32_bf16 v[120:123], v[16:19], v[88:91], v[120:123]
    v_mfma_f32_16x16x32_bf16 v[124:127], v[16:19], v[92:95], v[124:127]
    v_mfma_f32_16x16x32_bf16 v[128:131], v[16:19], v[96:99], v[128:131]
    v_mfma_f32_16x16x32_bf16 v[132:135], v[16:19], v[100:103], v[132:135]
    v_mfma_f32_16x16x32_bf16 v[136:139], v[16:19], v[104:107], v[136:139]
    v_mfma_f32_16x16x32_bf16 v[140:143], v[16:19], v[108:111], v[140:143]
    v_mfma_f32_16x16x32_bf16 v[144:147], v[16:19], v[112:115], v[144:147]
    v_mfma_f32_16x16x32_bf16 v[148:151], v[16:19], v[116:119], v[148:151]
    s_waitcnt vmcnt(3)
    s_add_u32 s78, s79, 1146880
    buffer_load_dwordx4 v[72:75], v6, s[56:59], s78 offen nt
    s_waitcnt vmcnt(3)
    s_add_u32 s78, s79, 1204224
    buffer_load_dwordx4 v[76:79], v6, s[56:59], s78 offen nt
    s_waitcnt vmcnt(3)
    s_add_u32 s78, s79, 1261568
    buffer_load_dwordx4 v[80:83], v6, s[56:59], s78 offen nt
    s_waitcnt vmcnt(3)
    s_add_u32 s78, s79, 1318912
    buffer_load_dwordx4 v[84:87], v6, s[56:59], s78 offen nt
    s_waitcnt vmcnt(3)
    s_add_u32 s78, s79, 1376256
    buffer_load_dwordx4 v[24:27], v6, s[52:55], s78 offen nt
    s_waitcnt vmcnt(3)
    s_add_u32 s78, s79, 1433600
    buffer_load_dwordx4 v[28:31], v6, s[52:55], s78 offen nt
    s_waitcnt vmcnt(3)
    s_add_u32 s78, s79, 1490944
    buffer_load_dwordx4 v[32:35], v6, s[52:55], s78 offen nt
    s_waitcnt vmcnt(3)
    s_add_u32 s78, s79, 1548288
    buffer_load_dwordx4 v[36:39], v6, s[52:55], s78 offen nt
    v_perm_b32 v88, v60, v56, s80
    v_perm_b32 v92, v60, v56, s81
    v_perm_b32 v96, v61, v57, s80
    v_perm_b32 v100, v61, v57, s81
    v_perm_b32 v104, v62, v58, s80
    v_perm_b32 v108, v62, v58, s81
    v_perm_b32 v112, v63, v59, s80
    v_perm_b32 v116, v63, v59, s81
    v_perm_b32 v89, v68, v64, s80
    v_perm_b32 v93, v68, v64, s81
    v_perm_b32 v97, v69, v65, s80
    v_perm_b32 v101, v69, v65, s81
    v_perm_b32 v105, v70, v66, s80
    v_perm_b32 v109, v70, v66, s81
    v_perm_b32 v113, v71, v67, s80
    v_perm_b32 v117, v71, v67, s81
    v_perm_b32 v90, v76, v72, s80
    v_perm_b32 v94, v76, v72, s81
    v_perm_b32 v98, v77, v73, s80
    v_perm_b32 v102, v77, v73, s81
    v_perm_b32 v106, v78, v74, s80
    v_perm_b32 v110, v78, v74, s81
    v_perm_b32 v114, v79, v75, s80
    v_perm_b32 v118, v79, v75, s81
    v_perm_b32 v91, v84, v80, s80
    v_perm_b32 v95, v84, v80, s81
    v_perm_b32 v99, v85, v81, s80
    v_perm_b32 v103, v85, v81, s81
    v_perm_b32 v107, v86, v82, s80
    v_perm_b32 v111, v86, v82, s81
    v_perm_b32 v115, v87, v83, s80
    v_perm_b32 v119, v87, v83, s81
    v_mfma_f32_16x16x32_bf16 v[152:155], v[16:19], v[88:91], v[152:155]
    v_mfma_f32_16x16x32_bf16 v[156:159], v[16:19], v[92:95], v[156:159]
    v_mfma_f32_16x16x32_bf16 v[160:163], v[16:19], v[96:99], v[160:163]
    v_mfma_f32_16x16x32_bf16 v[164:167], v[16:19], v[100:103], v[164:167]
    v_mfma_f32_16x16x32_bf16 v[168:171], v[16:19], v[104:107], v[168:171]
    v_mfma_f32_16x16x32_bf16 v[172:175], v[16:19], v[108:111], v[172:175]
    v_mfma_f32_16x16x32_bf16 v[176:179], v[16:19], v[112:115], v[176:179]
    v_mfma_f32_16x16x32_bf16 v[180:183], v[16:19], v[116:119], v[180:183]
    s_waitcnt vmcnt(3)
    s_add_u32 s78, s79, 1605632
    buffer_load_dwordx4 v[40:43], v6, s[52:55], s78 offen nt
    s_waitcnt vmcnt(3)
    s_add_u32 s78, s79, 1662976
    buffer_load_dwordx4 v[44:47], v6, s[52:55], s78 offen nt
    s_waitcnt vmcnt(3)
    s_add_u32 s78, s79, 1720320
    buffer_load_dwordx4 v[48:51], v6, s[52:55], s78 offen nt
    s_waitcnt vmcnt(3)
    s_add_u32 s78, s79, 1777664
    buffer_load_dwordx4 v[52:55], v6, s[52:55], s78 offen nt
    s_waitcnt vmcnt(3)
    s_add_u32 s78, s79, 1376256
    buffer_load_dwordx4 v[56:59], v6, s[56:59], s78 offen nt
    s_waitcnt vmcnt(3)
    s_add_u32 s78, s79, 1433600
    buffer_load_dwordx4 v[60:63], v6, s[56:59], s78 offen nt
    s_waitcnt vmcnt(3)
    s_add_u32 s78, s79, 1490944
    buffer_load_dwordx4 v[64:67], v6, s[56:59], s78 offen nt
    s_waitcnt vmcnt(3)
    s_add_u32 s78, s79, 1548288
    buffer_load_dwordx4 v[68:71], v6, s[56:59], s78 offen nt
    v_perm_b32 v88, v28, v24, s80
    v_perm_b32 v92, v28, v24, s81
    v_perm_b32 v96, v29, v25, s80
    v_perm_b32 v100, v29, v25, s81
    v_perm_b32 v104, v30, v26, s80
    v_perm_b32 v108, v30, v26, s81
    v_perm_b32 v112, v31, v27, s80
    v_perm_b32 v116, v31, v27, s81
    v_perm_b32 v89, v36, v32, s80
    v_perm_b32 v93, v36, v32, s81
    v_perm_b32 v97, v37, v33, s80
    v_perm_b32 v101, v37, v33, s81
    v_perm_b32 v105, v38, v34, s80
    v_perm_b32 v109, v38, v34, s81
    v_perm_b32 v113, v39, v35, s80
    v_perm_b32 v117, v39, v35, s81
    v_perm_b32 v90, v44, v40, s80
    v_perm_b32 v94, v44, v40, s81
    v_perm_b32 v98, v45, v41, s80
    v_perm_b32 v102, v45, v41, s81
    v_perm_b32 v106, v46, v42, s80
    v_perm_b32 v110, v46, v42, s81
    v_perm_b32 v114, v47, v43, s80
    v_perm_b32 v118, v47, v43, s81
    v_perm_b32 v91, v52, v48, s80
    v_perm_b32 v95, v52, v48, s81
    v_perm_b32 v99, v53, v49, s80
    v_perm_b32 v103, v53, v49, s81
    v_perm_b32 v107, v54, v50, s80
    v_perm_b32 v111, v54, v50, s81
    v_perm_b32 v115, v55, v51, s80
    v_perm_b32 v119, v55, v51, s81
    v_mfma_f32_16x16x32_bf16 v[120:123], v[20:23], v[88:91], v[120:123]
    v_mfma_f32_16x16x32_bf16 v[124:127], v[20:23], v[92:95], v[124:127]
    v_mfma_f32_16x16x32_bf16 v[128:131], v[20:23], v[96:99], v[128:131]
    v_mfma_f32_16x16x32_bf16 v[132:135], v[20:23], v[100:103], v[132:135]
    v_mfma_f32_16x16x32_bf16 v[136:139], v[20:23], v[104:107], v[136:139]
    v_mfma_f32_16x16x32_bf16 v[140:143], v[20:23], v[108:111], v[140:143]
    v_mfma_f32_16x16x32_bf16 v[144:147], v[20:23], v[112:115], v[144:147]
    v_mfma_f32_16x16x32_bf16 v[148:151], v[20:23], v[116:119], v[148:151]
    s_waitcnt vmcnt(3)
    s_add_u32 s78, s79, 1605632
    buffer_load_dwordx4 v[72:75], v6, s[56:59], s78 offen nt
    s_waitcnt vmcnt(3)
    s_add_u32 s78, s79, 1662976
    buffer_load_dwordx4 v[76:79], v6, s[56:59], s78 offen nt
    s_waitcnt vmcnt(3)
    s_add_u32 s78, s79, 1720320
    buffer_load_dwordx4 v[80:83], v6, s[56:59], s78 offen nt
    s_waitcnt vmcnt(3)
    s_add_u32 s78, s79, 1777664
    buffer_load_dwordx4 v[84:87], v6, s[56:59], s78 offen nt
    s_waitcnt vmcnt(3)
    s_waitcnt vmcnt(2)
    s_waitcnt vmcnt(1)
    s_waitcnt vmcnt(0)
    v_perm_b32 v88, v60, v56, s80
    v_perm_b32 v92, v60, v56, s81
    v_perm_b32 v96, v61, v57, s80
    v_perm_b32 v100, v61, v57, s81
    v_perm_b32 v104, v62, v58, s80
    v_perm_b32 v108, v62, v58, s81
    v_perm_b32 v112, v63, v59, s80
    v_perm_b32 v116, v63, v59, s81
    v_perm_b32 v89, v68, v64, s80
    v_perm_b32 v93, v68, v64, s81
    v_perm_b32 v97, v69, v65, s80
    v_perm_b32 v101, v69, v65, s81
    v_perm_b32 v105, v70, v66, s80
    v_perm_b32 v109, v70, v66, s81
    v_perm_b32 v113, v71, v67, s80
    v_perm_b32 v117, v71, v67, s81
    v_perm_b32 v90, v76, v72, s80
    v_perm_b32 v94, v76, v72, s81
    v_perm_b32 v98, v77, v73, s80
    v_perm_b32 v102, v77, v73, s81
    v_perm_b32 v106, v78, v74, s80
    v_perm_b32 v110, v78, v74, s81
    v_perm_b32 v114, v79, v75, s80
    v_perm_b32 v118, v79, v75, s81
    v_perm_b32 v91, v84, v80, s80
    v_perm_b32 v95, v84, v80, s81
    v_perm_b32 v99, v85, v81, s80
    v_perm_b32 v103, v85, v81, s81
    v_perm_b32 v107, v86, v82, s80
    v_perm_b32 v111, v86, v82, s81
    v_perm_b32 v115, v87, v83, s80
    v_perm_b32 v119, v87, v83, s81
    v_mfma_f32_16x16x32_bf16 v[152:155], v[20:23], v[88:91], v[152:155]
    v_mfma_f32_16x16x32_bf16 v[156:159], v[20:23], v[92:95], v[156:159]
    v_mfma_f32_16x16x32_bf16 v[160:163], v[20:23], v[96:99], v[160:163]
    v_mfma_f32_16x16x32_bf16 v[164:167], v[20:23], v[100:103], v[164:167]
    v_mfma_f32_16x16x32_bf16 v[168:171], v[20:23], v[104:107], v[168:171]
    v_mfma_f32_16x16x32_bf16 v[172:175], v[20:23], v[108:111], v[172:175]
    v_mfma_f32_16x16x32_bf16 v[176:179], v[20:23], v[112:115], v[176:179]
    v_mfma_f32_16x16x32_bf16 v[180:183], v[20:23], v[116:119], v[180:183]
    v_lshlrev_b32 v5, 10, v2
    v_and_b32 v3, 3, v0
    v_lshl_add_u32 v5, v3, 4, v5
    s_mov_b32 exec_lo, 0x00f0000f
    s_mov_b32 exec_hi, 0xf0000f00
    ds_write_b128 v5, v[120:123] offset:3584
    ds_write_b128 v5, v[124:127] offset:3648
    ds_write_b128 v5, v[128:131] offset:3712
    ds_write_b128 v5, v[132:135] offset:3776
    ds_write_b128 v5, v[136:139] offset:3840
    ds_write_b128 v5, v[140:143] offset:3904
    ds_write_b128 v5, v[144:147] offset:3968
    ds_write_b128 v5, v[148:151] offset:4032
    s_waitcnt lgkmcnt(0)
    ds_write_b128 v5, v[152:155] offset:4096
    ds_write_b128 v5, v[156:159] offset:4160
    ds_write_b128 v5, v[160:163] offset:4224
    ds_write_b128 v5, v[164:167] offset:4288
    ds_write_b128 v5, v[168:171] offset:4352
    ds_write_b128 v5, v[172:175] offset:4416
    ds_write_b128 v5, v[176:179] offset:4480
    ds_write_b128 v5, v[180:183] offset:4544
    s_waitcnt lgkmcnt(0)
    s_mov_b64 exec, -1
    v_lshlrev_b32 v5, 4, v0
    ds_read_b128 v[24:27], v5 offset:3584
    ds_read_b128 v[28:31], v5 offset:4608
    ds_read_b128 v[32:35], v5 offset:5632
    ds_read_b128 v[36:39], v5 offset:6656
    s_waitcnt lgkmcnt(0)
    v_add_f32 v24, v24, v28
    v_add_f32 v25, v25, v29
    v_add_f32 v26, v26, v30
    v_add_f32 v27, v27, v31
    v_add_f32 v24, v24, v32
    v_add_f32 v25, v25, v33
    v_add_f32 v26, v26, v34
    v_add_f32 v27, v27, v35
    v_add_f32 v24, v24, v36
    v_add_f32 v25, v25, v37
    v_add_f32 v26, v26, v38
    v_add_f32 v27, v27, v39
    v_mov_b32 v28, v24
    v_mov_b32 v29, v25
    v_mov_b32 v30, v26
    v_mov_b32 v31, v27
    v_permlane32_swap_b32 v24, v28
    v_permlane32_swap_b32 v25, v29
    v_permlane32_swap_b32 v26, v30
    v_permlane32_swap_b32 v27, v31
    v_mov_b32 v40, 0xc0135761
    v_mul_f32 v44, v24, v24
    v_fmamk_f32 v44, v44, 0xbdd2d3e8, v40
    v_mul_f32 v44, v44, v24
    v_mul_f32 v45, v25, v25
    v_fmamk_f32 v45, v45, 0xbdd2d3e8, v40
    v_mul_f32 v45, v45, v25
    v_mul_f32 v46, v26, v26
    v_fmamk_f32 v46, v46, 0xbdd2d3e8, v40
    v_mul_f32 v46, v46, v26
    v_mul_f32 v47, v27, v27
    v_fmamk_f32 v47, v47, 0xbdd2d3e8, v40
    v_mul_f32 v47, v47, v27
    v_exp_f32 v44, v44
    v_exp_f32 v45, v45
    v_exp_f32 v46, v46
    v_exp_f32 v47, v47
    v_add_f32 v44, 1.0, v44
    v_add_f32 v45, 1.0, v45
    v_add_f32 v46, 1.0, v46
    v_add_f32 v47, 1.0, v47
    v_rcp_f32 v44, v44
    v_rcp_f32 v45, v45
    v_rcp_f32 v46, v46
    v_rcp_f32 v47, v47
    v_mul_f32 v44, v44, v24
    v_mul_f32 v45, v45, v25
    v_mul_f32 v46, v46, v26
    v_mul_f32 v47, v47, v27
    v_mul_f32 v44, v44, v28
    v_mul_f32 v45, v45, v29
    v_mul_f32 v46, v46, v30
    v_mul_f32 v47, v47, v31
    v_bfi_b32 v44, v254, s68, v44
    v_bfi_b32 v45, v254, s69, v45
    v_bfi_b32 v46, v254, s70, v46
    v_bfi_b32 v47, v254, s71, v47
    v_and_b32 v3, 3, v0
    v_lshlrev_b32 v5, 3, v3
    v_bfe_u32 v3, v0, 2, 3
    v_add_u32 v5, v5, v3
    v_lshlrev_b32 v5, 4, v5
    s_lshl_b32 s76, s83, 9
    s_add_u32 s76, s76, 0x210000
    s_mov_b32 exec_hi, 0
    buffer_store_dwordx4 v[44:47], v5, s[48:51], s76 offen sc1
    s_mov_b32 exec_hi, -1
    s_nop 0
L_NO_FFNA:
    v_lshlrev_b32 v6, 13, v2
    v_lshl_add_u32 v6, v1, 4, v6
    s_mul_i32 s79, s28, 28672
    s_mov_b32 s82, 100000
L_CNT:
    ds_read_b32 v3, v4 offset:272
    s_waitcnt lgkmcnt(0)
    v_cmp_ne_u32 vcc, 4, v3
    s_nop 0
    s_nop 2
    s_cbranch_vccz L_CNT_done
    s_sleep 16
    s_sub_u32 s82, s82, 1
    s_cmp_lg_u32 s82, 0
    s_cbranch_scc1 L_CNT
L_CNT_done:
    ds_read_b128 v[144:147], v4 offset:288
    ds_read_b128 v[148:151], v4 offset:304
    s_add_u32 s78, s79, 0
    buffer_load_dwordx4 v[16:19], v6, s[60:63], s78 offen
    s_add_u32 s78, s79, 1024
    buffer_load_dwordx4 v[20:23], v6, s[60:63], s78 offen
    s_add_u32 s78, s79, 2048
    buffer_load_dwordx4 v[24:27], v6, s[60:63], s78 offen
    s_add_u32 s78, s79, 3072
    buffer_load_dwordx4 v[28:31], v6, s[60:63], s78 offen
    s_add_u32 s78, s79, 4096
    buffer_load_dwordx4 v[32:35], v6, s[60:63], s78 offen
    s_add_u32 s78, s79, 5120
    buffer_load_dwordx4 v[36:39], v6, s[60:63], s78 offen
    s_waitcnt lgkmcnt(0)
    v_max3_f32 v152, v144, v146, v148
    v_max_f32 v152, v152, v150
    v_sub_f32 v156, v144, v152
    v_sub_f32 v157, v146, v152
    v_sub_f32 v158, v148, v152
    v_sub_f32 v159, v150, v152
    v_exp_f32 v156, v156
    v_exp_f32 v157, v157
    v_exp_f32 v158, v158
    v_exp_f32 v159, v159
    v_mov_b32 v153, s74
    v_mov_b32 v155, s75
    v_mul_f32 v154, v156, v145
    v_fmac_f32 v154, v157, v147
    v_fmac_f32 v154, v158, v149
    v_fmac_f32 v154, v159, v151
    s_lshl_b32 s76, s46, 6
    s_add_u32 s76, s76, s28
    s_xor_b32 s77, s76, 1
    s_lshl_b32 s76, s76, 4
    s_add_u32 s76, s76, 0x200000
    s_lshl_b32 s77, s77, 4
    s_add_u32 s30, s77, 0x200000
    s_mov_b64 exec, 1
    buffer_store_dwordx4 v[152:155], v4, s[48:51], s76 offen sc1
    s_mov_b64 exec, -1
    v_lshlrev_b32 v163, 4, v0
    s_mul_i32 s76, s28, 448
    s_add_u32 s76, s76, 0x210000
    s_mov_b64 exec, 0x0fffffff
    s_mov_b32 s82, 100000
L_HSPIN:
    buffer_load_dwordx4 v[164:167], v163, s[48:51], s76 offen sc1
    s_waitcnt vmcnt(0)
    v_xor_b32 v164, s68, v164
    v_xor_b32 v165, s69, v165
    v_xor_b32 v166, s70, v166
    v_xor_b32 v167, s71, v167
    v_or_b32 v160, v164, v165
    v_or3_b32 v160, v160, v166, v167
    v_and_b32 v160, 0x3ff, v160
    v_cmp_ne_u32 vcc, 0, v160
    s_nop 0
    s_nop 2
    s_cbranch_vccz L_HSPIN_done
    s_sleep 16
    s_sub_u32 s82, s82, 1
    s_cmp_lg_u32 s82, 0
    s_cbranch_scc1 L_HSPIN
L_HSPIN_done:
    s_mov_b64 exec, -1
    s_cmp_eq_u32 s46, 1
    s_cselect_b64 s[76:77], -1, 0
    v_cndmask_b32_e64 v164, v164, v165, s[76:77]
    s_cmp_eq_u32 s46, 2
    s_cselect_b64 s[76:77], -1, 0
    v_cndmask_b32_e64 v164, v164, v166, s[76:77]
    s_cmp_eq_u32 s46, 3
    s_cselect_b64 s[76:77], -1, 0
    v_cndmask_b32_e64 v164, v164, v167, s[76:77]
    v_cmp_gt_u32 vcc, 28, v0
    s_nop 1
    v_cndmask_b32 v164, 0, v164, vcc
    v_cvt_pk_bf16_f32 v164, v164, v164
    v_lshlrev_b32 v161, 1, v0
    s_mov_b32 exec_hi, 0
    ds_write_b16 v161, v164 offset:336
    s_mov_b32 exec_hi, -1
    v_lshlrev_b32 v161, 4, v2
    s_waitcnt lgkmcnt(0)
    ds_read_b128 v[8:11], v161 offset:336
    v_lshlrev_b32 v162, 5, v1
    s_waitcnt lgkmcnt(0)
    s_add_u32 s78, s79, 6144
    buffer_load_dwordx4 v[40:43], v6, s[60:63], s78 offen
    s_add_u32 s78, s79, 7168
    buffer_load_dwordx4 v[44:47], v6, s[60:63], s78 offen
    s_add_u32 s78, s79, 256
    buffer_load_dwordx4 v[48:51], v6, s[60:63], s78 offen
    s_add_u32 s78, s79, 1280
    buffer_load_dwordx4 v[52:55], v6, s[60:63], s78 offen
    s_add_u32 s78, s79, 2304
    buffer_load_dwordx4 v[56:59], v6, s[60:63], s78 offen
    s_add_u32 s78, s79, 3328
    buffer_load_dwordx4 v[60:63], v6, s[60:63], s78 offen
    s_waitcnt vmcnt(5)
    s_add_u32 s78, s79, 4352
    buffer_load_dwordx4 v[64:67], v6, s[60:63], s78 offen
    s_waitcnt vmcnt(5)
    s_add_u32 s78, s79, 5376
    buffer_load_dwordx4 v[68:71], v6, s[60:63], s78 offen
    v_perm_b32 v80, v20, v16, s80
    v_perm_b32 v84, v20, v16, s81
    v_perm_b32 v88, v21, v17, s80
    v_perm_b32 v92, v21, v17, s81
    v_perm_b32 v96, v22, v18, s80
    v_perm_b32 v100, v22, v18, s81
    v_perm_b32 v104, v23, v19, s80
    v_perm_b32 v108, v23, v19, s81
    v_perm_b32 v81, v28, v24, s80
    v_perm_b32 v85, v28, v24, s81
    v_perm_b32 v89, v29, v25, s80
    v_perm_b32 v93, v29, v25, s81
    v_perm_b32 v97, v30, v26, s80
    v_perm_b32 v101, v30, v26, s81
    v_perm_b32 v105, v31, v27, s80
    v_perm_b32 v109, v31, v27, s81
    v_perm_b32 v82, v36, v32, s80
    v_perm_b32 v86, v36, v32, s81
    v_perm_b32 v90, v37, v33, s80
    v_perm_b32 v94, v37, v33, s81
    v_perm_b32 v98, v38, v34, s80
    v_perm_b32 v102, v38, v34, s81
    v_perm_b32 v106, v39, v35, s80
    v_perm_b32 v110, v39, v35, s81
    v_perm_b32 v83, v44, v40, s80
    v_perm_b32 v87, v44, v40, s81
    v_perm_b32 v91, v45, v41, s80
    v_perm_b32 v95, v45, v41, s81
    v_perm_b32 v99, v46, v42, s80
    v_perm_b32 v103, v46, v42, s81
    v_perm_b32 v107, v47, v43, s80
    v_perm_b32 v111, v47, v43, s81
    v_mfma_f32_16x16x32_bf16 v[112:115], v[8:11], v[80:83], 0
    v_mfma_f32_16x16x32_bf16 v[116:119], v[8:11], v[84:87], 0
    v_mfma_f32_16x16x32_bf16 v[120:123], v[8:11], v[88:91], 0
    v_mfma_f32_16x16x32_bf16 v[124:127], v[8:11], v[92:95], 0
    v_mfma_f32_16x16x32_bf16 v[128:131], v[8:11], v[96:99], 0
    v_mfma_f32_16x16x32_bf16 v[132:135], v[8:11], v[100:103], 0
    v_mfma_f32_16x16x32_bf16 v[136:139], v[8:11], v[104:107], 0
    v_mfma_f32_16x16x32_bf16 v[140:143], v[8:11], v[108:111], 0
    s_nop 0
    v_mul_f32 v168, v251, v112
    v_mul_f32 v169, v251, v116
    v_mul_f32 v170, v251, v120
    v_mul_f32 v171, v251, v124
    v_mul_f32 v172, v251, v128
    v_mul_f32 v173, v251, v132
    v_mul_f32 v174, v251, v136
    v_mul_f32 v175, v251, v140
    s_mov_b64 exec, 0xffff
    ds_write_b128 v162, v[168:171] offset:1536
    ds_write_b128 v162, v[172:175] offset:1552
    s_mov_b64 exec, -1
    s_waitcnt vmcnt(5)
    s_add_u32 s78, s79, 6400
    buffer_load_dwordx4 v[72:75], v6, s[60:63], s78 offen
    s_waitcnt vmcnt(5)
    s_add_u32 s78, s79, 7424
    buffer_load_dwordx4 v[76:79], v6, s[60:63], s78 offen
    s_waitcnt vmcnt(5)
    s_add_u32 s78, s79, 512
    buffer_load_dwordx4 v[16:19], v6, s[60:63], s78 offen
    s_waitcnt vmcnt(5)
    s_add_u32 s78, s79, 1536
    buffer_load_dwordx4 v[20:23], v6, s[60:63], s78 offen
    s_waitcnt vmcnt(5)
    s_add_u32 s78, s79, 2560
    buffer_load_dwordx4 v[24:27], v6, s[60:63], s78 offen
    s_waitcnt vmcnt(5)
    s_add_u32 s78, s79, 3584
    buffer_load_dwordx4 v[28:31], v6, s[60:63], s78 offen
    s_waitcnt vmcnt(5)
    s_add_u32 s78, s79, 4608
    buffer_load_dwordx4 v[32:35], v6, s[60:63], s78 offen
    s_waitcnt vmcnt(5)
    s_add_u32 s78, s79, 5632
    buffer_load_dwordx4 v[36:39], v6, s[60:63], s78 offen
    v_perm_b32 v80, v52, v48, s80
    v_perm_b32 v84, v52, v48, s81
    v_perm_b32 v88, v53, v49, s80
    v_perm_b32 v92, v53, v49, s81
    v_perm_b32 v96, v54, v50, s80
    v_perm_b32 v100, v54, v50, s81
    v_perm_b32 v104, v55, v51, s80
    v_perm_b32 v108, v55, v51, s81
    v_perm_b32 v81, v60, v56, s80
    v_perm_b32 v85, v60, v56, s81
    v_perm_b32 v89, v61, v57, s80
    v_perm_b32 v93, v61, v57, s81
    v_perm_b32 v97, v62, v58, s80
    v_perm_b32 v101, v62, v58, s81
    v_perm_b32 v105, v63, v59, s80
    v_perm_b32 v109, v63, v59, s81
    v_perm_b32 v82, v68, v64, s80
    v_perm_b32 v86, v68, v64, s81
    v_perm_b32 v90, v69, v65, s80
    v_perm_b32 v94, v69, v65, s81
    v_perm_b32 v98, v70, v66, s80
    v_perm_b32 v102, v70, v66, s81
    v_perm_b32 v106, v71, v67, s80
    v_perm_b32 v110, v71, v67, s81
    v_perm_b32 v83, v76, v72, s80
    v_perm_b32 v87, v76, v72, s81
    v_perm_b32 v91, v77, v73, s80
    v_perm_b32 v95, v77, v73, s81
    v_perm_b32 v99, v78, v74, s80
    v_perm_b32 v103, v78, v74, s81
    v_perm_b32 v107, v79, v75, s80
    v_perm_b32 v111, v79, v75, s81
    v_mfma_f32_16x16x32_bf16 v[112:115], v[8:11], v[80:83], 0
    v_mfma_f32_16x16x32_bf16 v[116:119], v[8:11], v[84:87], 0
    v_mfma_f32_16x16x32_bf16 v[120:123], v[8:11], v[88:91], 0
    v_mfma_f32_16x16x32_bf16 v[124:127], v[8:11], v[92:95], 0
    v_mfma_f32_16x16x32_bf16 v[128:131], v[8:11], v[96:99], 0
    v_mfma_f32_16x16x32_bf16 v[132:135], v[8:11], v[100:103], 0
    v_mfma_f32_16x16x32_bf16 v[136:139], v[8:11], v[104:107], 0
    v_mfma_f32_16x16x32_bf16 v[140:143], v[8:11], v[108:111], 0
    s_nop 0
    v_mul_f32 v168, v251, v112
    v_mul_f32 v169, v251, v116
    v_mul_f32 v170, v251, v120
    v_mul_f32 v171, v251, v124
    v_mul_f32 v172, v251, v128
    v_mul_f32 v173, v251, v132
    v_mul_f32 v174, v251, v136
    v_mul_f32 v175, v251, v140
    s_mov_b64 exec, 0xffff
    ds_write_b128 v162, v[168:171] offset:2048
    ds_write_b128 v162, v[172:175] offset:2064
    s_mov_b64 exec, -1
    s_waitcnt vmcnt(5)
    s_add_u32 s78, s79, 6656
    buffer_load_dwordx4 v[40:43], v6, s[60:63], s78 offen
    s_waitcnt vmcnt(5)
    s_add_u32 s78, s79, 7680
    buffer_load_dwordx4 v[44:47], v6, s[60:63], s78 offen
    s_waitcnt vmcnt(5)
    s_add_u32 s78, s79, 768
    buffer_load_dwordx4 v[48:51], v6, s[60:63], s78 offen
    s_waitcnt vmcnt(5)
    s_add_u32 s78, s79, 1792
    buffer_load_dwordx4 v[52:55], v6, s[60:63], s78 offen
    s_waitcnt vmcnt(5)
    s_add_u32 s78, s79, 2816
    buffer_load_dwordx4 v[56:59], v6, s[60:63], s78 offen
    s_waitcnt vmcnt(5)
    s_add_u32 s78, s79, 3840
    buffer_load_dwordx4 v[60:63], v6, s[60:63], s78 offen
    s_waitcnt vmcnt(5)
    s_add_u32 s78, s79, 4864
    buffer_load_dwordx4 v[64:67], v6, s[60:63], s78 offen
    s_waitcnt vmcnt(5)
    s_add_u32 s78, s79, 5888
    buffer_load_dwordx4 v[68:71], v6, s[60:63], s78 offen
    v_perm_b32 v80, v20, v16, s80
    v_perm_b32 v84, v20, v16, s81
    v_perm_b32 v88, v21, v17, s80
    v_perm_b32 v92, v21, v17, s81
    v_perm_b32 v96, v22, v18, s80
    v_perm_b32 v100, v22, v18, s81
    v_perm_b32 v104, v23, v19, s80
    v_perm_b32 v108, v23, v19, s81
    v_perm_b32 v81, v28, v24, s80
    v_perm_b32 v85, v28, v24, s81
    v_perm_b32 v89, v29, v25, s80
    v_perm_b32 v93, v29, v25, s81
    v_perm_b32 v97, v30, v26, s80
    v_perm_b32 v101, v30, v26, s81
    v_perm_b32 v105, v31, v27, s80
    v_perm_b32 v109, v31, v27, s81
    v_perm_b32 v82, v36, v32, s80
    v_perm_b32 v86, v36, v32, s81
    v_perm_b32 v90, v37, v33, s80
    v_perm_b32 v94, v37, v33, s81
    v_perm_b32 v98, v38, v34, s80
    v_perm_b32 v102, v38, v34, s81
    v_perm_b32 v106, v39, v35, s80
    v_perm_b32 v110, v39, v35, s81
    v_perm_b32 v83, v44, v40, s80
    v_perm_b32 v87, v44, v40, s81
    v_perm_b32 v91, v45, v41, s80
    v_perm_b32 v95, v45, v41, s81
    v_perm_b32 v99, v46, v42, s80
    v_perm_b32 v103, v46, v42, s81
    v_perm_b32 v107, v47, v43, s80
    v_perm_b32 v111, v47, v43, s81
    v_mfma_f32_16x16x32_bf16 v[112:115], v[8:11], v[80:83], 0
    v_mfma_f32_16x16x32_bf16 v[116:119], v[8:11], v[84:87], 0
    v_mfma_f32_16x16x32_bf16 v[120:123], v[8:11], v[88:91], 0
    v_mfma_f32_16x16x32_bf16 v[124:127], v[8:11], v[92:95], 0
    v_mfma_f32_16x16x32_bf16 v[128:131], v[8:11], v[96:99], 0
    v_mfma_f32_16x16x32_bf16 v[132:135], v[8:11], v[100:103], 0
    v_mfma_f32_16x16x32_bf16 v[136:139], v[8:11], v[104:107], 0
    v_mfma_f32_16x16x32_bf16 v[140:143], v[8:11], v[108:111], 0
    s_nop 0
    v_mul_f32 v168, v251, v112
    v_mul_f32 v169, v251, v116
    v_mul_f32 v170, v251, v120
    v_mul_f32 v171, v251, v124
    v_mul_f32 v172, v251, v128
    v_mul_f32 v173, v251, v132
    v_mul_f32 v174, v251, v136
    v_mul_f32 v175, v251, v140
    s_mov_b64 exec, 0xffff
    ds_write_b128 v162, v[168:171] offset:2560
    ds_write_b128 v162, v[172:175] offset:2576
    s_mov_b64 exec, -1
    s_waitcnt vmcnt(5)
    s_add_u32 s78, s79, 6912
    buffer_load_dwordx4 v[72:75], v6, s[60:63], s78 offen
    s_waitcnt vmcnt(5)
    s_add_u32 s78, s79, 7936
    buffer_load_dwordx4 v[76:79], v6, s[60:63], s78 offen
    s_waitcnt vmcnt(5)
    s_waitcnt vmcnt(4)
    s_waitcnt vmcnt(3)
    s_waitcnt vmcnt(2)
    s_waitcnt vmcnt(1)
    s_waitcnt vmcnt(0)
    v_perm_b32 v80, v52, v48, s80
    v_perm_b32 v84, v52, v48, s81
    v_perm_b32 v88, v53, v49, s80
    v_perm_b32 v92, v53, v49, s81
    v_perm_b32 v96, v54, v50, s80
    v_perm_b32 v100, v54, v50, s81
    v_perm_b32 v104, v55, v51, s80
    v_perm_b32 v108, v55, v51, s81
    v_perm_b32 v81, v60, v56, s80
    v_perm_b32 v85, v60, v56, s81
    v_perm_b32 v89, v61, v57, s80
    v_perm_b32 v93, v61, v57, s81
    v_perm_b32 v97, v62, v58, s80
    v_perm_b32 v101, v62, v58, s81
    v_perm_b32 v105, v63, v59, s80
    v_perm_b32 v109, v63, v59, s81
    v_perm_b32 v82, v68, v64, s80
    v_perm_b32 v86, v68, v64, s81
    v_perm_b32 v90, v69, v65, s80
    v_perm_b32 v94, v69, v65, s81
    v_perm_b32 v98, v70, v66, s80
    v_perm_b32 v102, v70, v66, s81
    v_perm_b32 v106, v71, v67, s80
    v_perm_b32 v110, v71, v67, s81
    v_perm_b32 v83, v76, v72, s80
    v_perm_b32 v87, v76, v72, s81
    v_perm_b32 v91, v77, v73, s80
    v_perm_b32 v95, v77, v73, s81
    v_perm_b32 v99, v78, v74, s80
    v_perm_b32 v103, v78, v74, s81
    v_perm_b32 v107, v79, v75, s80
    v_perm_b32 v111, v79, v75, s81
    v_mfma_f32_16x16x32_bf16 v[112:115], v[8:11], v[80:83], 0
    v_mfma_f32_16x16x32_bf16 v[116:119], v[8:11], v[84:87], 0
    v_mfma_f32_16x16x32_bf16 v[120:123], v[8:11], v[88:91], 0
    v_mfma_f32_16x16x32_bf16 v[124:127], v[8:11], v[92:95], 0
    v_mfma_f32_16x16x32_bf16 v[128:131], v[8:11], v[96:99], 0
    v_mfma_f32_16x16x32_bf16 v[132:135], v[8:11], v[100:103], 0
    v_mfma_f32_16x16x32_bf16 v[136:139], v[8:11], v[104:107], 0
    v_mfma_f32_16x16x32_bf16 v[140:143], v[8:11], v[108:111], 0
    s_nop 0
    v_mul_f32 v168, v251, v112
    v_mul_f32 v169, v251, v116
    v_mul_f32 v170, v251, v120
    v_mul_f32 v171, v251, v124
    v_mul_f32 v172, v251, v128
    v_mul_f32 v173, v251, v132
    v_mul_f32 v174, v251, v136
    v_mul_f32 v175, v251, v140
    s_mov_b64 exec, 0xffff
    ds_write_b128 v162, v[168:171] offset:3072
    ds_write_b128 v162, v[172:175] offset:3088
    s_mov_b64 exec, -1
    s_mov_b64 exec, 1
    s_mov_b32 s82, 100000
L_PSPIN:
    buffer_load_dwordx4 v[164:167], v4, s[48:51], s30 offen sc1
    s_waitcnt vmcnt(0)
    v_xor_b32 v161, s74, v165
    v_xor_b32 v162, s75, v167
    v_or_b32 v160, v161, v162
    v_cmp_ne_u32 vcc, 0, v160
    s_nop 0
    s_nop 2
    s_cbranch_vccz L_PSPIN_done
    s_sleep 16
    s_sub_u32 s82, s82, 1
    s_cmp_lg_u32 s82, 0
    s_cbranch_scc1 L_PSPIN
L_PSPIN_done:
    v_max_f32 v160, v152, v164
    v_sub_f32 v152, v152, v160
    v_sub_f32 v164, v164, v160
    v_exp_f32 v152, v152
    v_exp_f32 v164, v164
    v_mul_f32 v154, v152, v154
    v_fmac_f32 v154, v164, v166
    v_rcp_f32 v154, v154
    v_mul_f32 v152, v152, v250
    v_mul_f32 v152, v152, v154
    v_mul_f32 v156, v156, v152
    v_mul_f32 v157, v157, v152
    v_mul_f32 v158, v158, v152
    v_mul_f32 v159, v159, v152
    ds_write_b128 v4, v[156:159] offset:320
    s_mov_b64 exec, -1
    s_lshr_b32 s83, s44, 1
    s_lshl_b32 s76, s46, 4
    s_add_u32 s76, s76, s83
    s_lshl_b32 s77, s76, 13
    s_add_u32 s77, s77, 0x100000
    v_lshlrev_b32 v5, 4, v0
    s_lshl_b32 s76, s46, 10
    s_lshl_b32 s78, s83, 6
    s_add_u32 s76, s76, s78
    v_lshlrev_b32 v15, 3, v0
    v_add_u32 v15, s76, v15
    s_waitcnt lgkmcnt(0)
    s_barrier
    s_and_b32 s76, s43, s47
    s_and_b32 s76, s76, 1
    s_cmp_lg_u32 s76, 0
    s_cbranch_scc1 L_RED
    s_endpgm
L_RED:
    s_setprio 3
    s_mov_b32 s82, 100000
    s_add_u32 s78, s77, 0
    buffer_load_dwordx4 v[16:19], v5, s[48:51], s78 offen offset:0 sc1
    buffer_load_dwordx4 v[20:23], v5, s[48:51], s78 offen offset:1024 sc1
    buffer_load_dwordx4 v[24:27], v5, s[48:51], s78 offen offset:2048 sc1
    buffer_load_dwordx4 v[28:31], v5, s[48:51], s78 offen offset:3072 sc1
    s_add_u32 s78, s77, 4096
    buffer_load_dwordx4 v[32:35], v5, s[48:51], s78 offen offset:0 sc1
    buffer_load_dwordx4 v[36:39], v5, s[48:51], s78 offen offset:1024 sc1
    buffer_load_dwordx4 v[40:43], v5, s[48:51], s78 offen offset:2048 sc1
    buffer_load_dwordx4 v[44:47], v5, s[48:51], s78 offen offset:3072 sc1
L_YSPIN:
    s_add_u32 s78, s77, 0
    buffer_load_dwordx4 v[48:51], v5, s[48:51], s78 offen offset:0 sc1
    buffer_load_dwordx4 v[52:55], v5, s[48:51], s78 offen offset:1024 sc1
    buffer_load_dwordx4 v[56:59], v5, s[48:51], s78 offen offset:2048 sc1
    buffer_load_dwordx4 v[60:63], v5, s[48:51], s78 offen offset:3072 sc1
    s_add_u32 s78, s77, 4096
    buffer_load_dwordx4 v[64:67], v5, s[48:51], s78 offen offset:0 sc1
    buffer_load_dwordx4 v[68:71], v5, s[48:51], s78 offen offset:1024 sc1
    buffer_load_dwordx4 v[72:75], v5, s[48:51], s78 offen offset:2048 sc1
    buffer_load_dwordx4 v[76:79], v5, s[48:51], s78 offen offset:3072 sc1
    s_waitcnt vmcnt(8)
    v_xor_b32 v16, s68, v16
    v_xor_b32 v17, s69, v17
    v_xor_b32 v18, s70, v18
    v_xor_b32 v19, s71, v19
    v_or_b32 v8, v16, v17
    v_or3_b32 v8, v8, v18, v19
    v_xor_b32 v20, s68, v20
    v_xor_b32 v21, s69, v21
    v_xor_b32 v22, s70, v22
    v_xor_b32 v23, s71, v23
    v_or3_b32 v8, v8, v20, v21
    v_or3_b32 v8, v8, v22, v23
    v_xor_b32 v24, s68, v24
    v_xor_b32 v25, s69, v25
    v_xor_b32 v26, s70, v26
    v_xor_b32 v27, s71, v27
    v_or3_b32 v8, v8, v24, v25
    v_or3_b32 v8, v8, v26, v27
    v_xor_b32 v28, s68, v28
    v_xor_b32 v29, s69, v29
    v_xor_b32 v30, s70, v30
    v_xor_b32 v31, s71, v31
    v_or3_b32 v8, v8, v28, v29
    v_or3_b32 v8, v8, v30, v31
    v_xor_b32 v32, s68, v32
    v_xor_b32 v33, s69, v33
    v_xor_b32 v34, s70, v34
    v_xor_b32 v35, s71, v35
    v_or3_b32 v8, v8, v32, v33
    v_or3_b32 v8, v8, v34, v35
    v_xor_b32 v36, s68, v36
    v_xor_b32 v37, s69, v37
    v_xor_b32 v38, s70, v38
    v_xor_b32 v39, s71, v39
    v_or3_b32 v8, v8, v36, v37
    v_or3_b32 v8, v8, v38, v39
    v_xor_b32 v40, s68, v40
    v_xor_b32 v41, s69, v41
    v_xor_b32 v42, s70, v42
    v_xor_b32 v43, s71, v43
    v_or3_b32 v8, v8, v40, v41
    v_or3_b32 v8, v8, v42, v43
    v_xor_b32 v44, s68, v44
    v_xor_b32 v45, s69, v45
    v_xor_b32 v46, s70, v46
    v_xor_b32 v47, s71, v47
    v_or3_b32 v8, v8, v44, v45
    v_or3_b32 v8, v8, v46, v47
    v_and_b32 v8, 0x3ff, v8
    v_cmp_ne_u32 vcc, 0, v8
    s_nop 0
    s_nop 2
    s_cbranch_vccz L_YDONE_A
    s_add_u32 s78, s77, 0
    buffer_load_dwordx4 v[16:19], v5, s[48:51], s78 offen offset:0 sc1
    buffer_load_dwordx4 v[20:23], v5, s[48:51], s78 offen offset:1024 sc1
    buffer_load_dwordx4 v[24:27], v5, s[48:51], s78 offen offset:2048 sc1
    buffer_load_dwordx4 v[28:31], v5, s[48:51], s78 offen offset:3072 sc1
    s_add_u32 s78, s77, 4096
    buffer_load_dwordx4 v[32:35], v5, s[48:51], s78 offen offset:0 sc1
    buffer_load_dwordx4 v[36:39], v5, s[48:51], s78 offen offset:1024 sc1
    buffer_load_dwordx4 v[40:43], v5, s[48:51], s78 offen offset:2048 sc1
    buffer_load_dwordx4 v[44:47], v5, s[48:51], s78 offen offset:3072 sc1
    s_waitcnt vmcnt(8)
    v_xor_b32 v48, s68, v48
    v_xor_b32 v49, s69, v49
    v_xor_b32 v50, s70, v50
    v_xor_b32 v51, s71, v51
    v_or_b32 v8, v48, v49
    v_or3_b32 v8, v8, v50, v51
    v_xor_b32 v52, s68, v52
    v_xor_b32 v53, s69, v53
    v_xor_b32 v54, s70, v54
    v_xor_b32 v55, s71, v55
    v_or3_b32 v8, v8, v52, v53
    v_or3_b32 v8, v8, v54, v55
    v_xor_b32 v56, s68, v56
    v_xor_b32 v57, s69, v57
    v_xor_b32 v58, s70, v58
    v_xor_b32 v59, s71, v59
    v_or3_b32 v8, v8, v56, v57
    v_or3_b32 v8, v8, v58, v59
    v_xor_b32 v60, s68, v60
    v_xor_b32 v61, s69, v61
    v_xor_b32 v62, s70, v62
    v_xor_b32 v63, s71, v63
    v_or3_b32 v8, v8, v60, v61
    v_or3_b32 v8, v8, v62, v63
    v_xor_b32 v64, s68, v64
    v_xor_b32 v65, s69, v65
    v_xor_b32 v66, s70, v66
    v_xor_b32 v67, s71, v67
    v_or3_b32 v8, v8, v64, v65
    v_or3_b32 v8, v8, v66, v67
    v_xor_b32 v68, s68, v68
    v_xor_b32 v69, s69, v69
    v_xor_b32 v70, s70, v70
    v_xor_b32 v71, s71, v71
    v_or3_b32 v8, v8, v68, v69
    v_or3_b32 v8, v8, v70, v71
    v_xor_b32 v72, s68, v72
    v_xor_b32 v73, s69, v73
    v_xor_b32 v74, s70, v74
    v_xor_b32 v75, s71, v75
    v_or3_b32 v8, v8, v72, v73
    v_or3_b32 v8, v8, v74, v75
    v_xor_b32 v76, s68, v76
    v_xor_b32 v77, s69, v77
    v_xor_b32 v78, s70, v78
    v_xor_b32 v79, s71, v79
    v_or3_b32 v8, v8, v76, v77
    v_or3_b32 v8, v8, v78, v79
    v_and_b32 v8, 0x3ff, v8
    v_cmp_ne_u32 vcc, 0, v8
    s_nop 0
    s_nop 2
    s_cbranch_vccz L_YDONE_B
    s_sub_u32 s82, s82, 1
    s_cmp_lg_u32 s82, 0
    s_cbranch_scc1 L_YSPIN
L_YDONE_B:
    v_add_f32 v48, v48, v52
    v_add_f32 v49, v49, v53
    v_add_f32 v50, v50, v54
    v_add_f32 v51, v51, v55
    v_add_f32 v56, v56, v60
    v_add_f32 v57, v57, v61
    v_add_f32 v58, v58, v62
    v_add_f32 v59, v59, v63
    v_add_f32 v64, v64, v68
    v_add_f32 v65, v65, v69
    v_add_f32 v66, v66, v70
    v_add_f32 v67, v67, v71
    v_add_f32 v72, v72, v76
    v_add_f32 v73, v73, v77
    v_add_f32 v74, v74, v78
    v_add_f32 v75, v75, v79
    v_add_f32 v48, v48, v56
    v_add_f32 v49, v49, v57
    v_add_f32 v50, v50, v58
    v_add_f32 v51, v51, v59
    v_add_f32 v64, v64, v72
    v_add_f32 v65, v65, v73
    v_add_f32 v66, v66, v74
    v_add_f32 v67, v67, v75
    v_add_f32 v48, v48, v64
    v_add_f32 v49, v49, v65
    v_add_f32 v50, v50, v66
    v_add_f32 v51, v51, v67
    v_add_f32_dpp v48, v48, v48 row_ror:8 row_mask:0xf bank_mask:0xf
    v_add_f32_dpp v49, v49, v49 row_ror:8 row_mask:0xf bank_mask:0xf
    v_add_f32_dpp v50, v50, v50 row_ror:8 row_mask:0xf bank_mask:0xf
    v_add_f32_dpp v51, v51, v51 row_ror:8 row_mask:0xf bank_mask:0xf
    v_mov_b32 v52, v48
    v_mov_b32 v53, v49
    v_mov_b32 v54, v50
    v_mov_b32 v55, v51
    v_permlane16_swap_b32 v48, v52
    v_permlane16_swap_b32 v49, v53
    v_permlane16_swap_b32 v50, v54
    v_permlane16_swap_b32 v51, v55
    v_add_f32 v48, v48, v52
    v_add_f32 v49, v49, v53
    v_add_f32 v50, v50, v54
    v_add_f32 v51, v51, v55
    v_mov_b32 v52, v48
    v_mov_b32 v53, v49
    v_mov_b32 v54, v50
    v_mov_b32 v55, v51
    v_permlane32_swap_b32 v48, v52
    v_permlane32_swap_b32 v49, v53
    v_permlane32_swap_b32 v50, v54
    v_permlane32_swap_b32 v51, v55
    v_add_f32 v48, v48, v52
    v_add_f32 v49, v49, v53
    v_add_f32 v50, v50, v54
    v_add_f32 v51, v51, v55
    v_cvt_pk_bf16_f32 v48, v48, v49
    v_cvt_pk_bf16_f32 v49, v50, v51
    s_mov_b64 exec, 0xff
    buffer_store_dwordx2 v[48:49], v15, s[64:67], 0 offen sc1
    s_branch L_YFIN
L_YDONE_A:
    v_add_f32 v16, v16, v20
    v_add_f32 v17, v17, v21
    v_add_f32 v18, v18, v22
    v_add_f32 v19, v19, v23
    v_add_f32 v24, v24, v28
    v_add_f32 v25, v25, v29
    v_add_f32 v26, v26, v30
    v_add_f32 v27, v27, v31
    v_add_f32 v32, v32, v36
    v_add_f32 v33, v33, v37
    v_add_f32 v34, v34, v38
    v_add_f32 v35, v35, v39
    v_add_f32 v40, v40, v44
    v_add_f32 v41, v41, v45
    v_add_f32 v42, v42, v46
    v_add_f32 v43, v43, v47
    v_add_f32 v16, v16, v24
    v_add_f32 v17, v17, v25
    v_add_f32 v18, v18, v26
    v_add_f32 v19, v19, v27
    v_add_f32 v32, v32, v40
    v_add_f32 v33, v33, v41
    v_add_f32 v34, v34, v42
    v_add_f32 v35, v35, v43
    v_add_f32 v16, v16, v32
    v_add_f32 v17, v17, v33
    v_add_f32 v18, v18, v34
    v_add_f32 v19, v19, v35
    v_add_f32_dpp v16, v16, v16 row_ror:8 row_mask:0xf bank_mask:0xf
    v_add_f32_dpp v17, v17, v17 row_ror:8 row_mask:0xf bank_mask:0xf
    v_add_f32_dpp v18, v18, v18 row_ror:8 row_mask:0xf bank_mask:0xf
    v_add_f32_dpp v19, v19, v19 row_ror:8 row_mask:0xf bank_mask:0xf
    v_mov_b32 v20, v16
    v_mov_b32 v21, v17
    v_mov_b32 v22, v18
    v_mov_b32 v23, v19
    v_permlane16_swap_b32 v16, v20
    v_permlane16_swap_b32 v17, v21
    v_permlane16_swap_b32 v18, v22
    v_permlane16_swap_b32 v19, v23
    v_add_f32 v16, v16, v20
    v_add_f32 v17, v17, v21
    v_add_f32 v18, v18, v22
    v_add_f32 v19, v19, v23
    v_mov_b32 v20, v16
    v_mov_b32 v21, v17
    v_mov_b32 v22, v18
    v_mov_b32 v23, v19
    v_permlane32_swap_b32 v16, v20
    v_permlane32_swap_b32 v17, v21
    v_permlane32_swap_b32 v18, v22
    v_permlane32_swap_b32 v19, v23
    v_add_f32 v16, v16, v20
    v_add_f32 v17, v17, v21
    v_add_f32 v18, v18, v22
    v_add_f32 v19, v19, v23
    v_cvt_pk_bf16_f32 v16, v16, v17
    v_cvt_pk_bf16_f32 v17, v18, v19
    s_mov_b64 exec, 0xff
    buffer_store_dwordx2 v[16:17], v15, s[64:67], 0 offen sc1
L_YFIN:
    s_or_b32 s76, s46, s83
    s_cmp_lg_u32 s76, 0
    s_cbranch_scc1 L_RED_END
    s_mov_b32 s52, s38
    s_and_b32 s53, s39, 0xffff
    s_mov_b32 s54, 0x100
    s_mov_b32 s55, 0x20000
    s_mov_b64 exec, 1
    v_mov_b32 v8, 0
    v_mov_b32 v9, 0
    buffer_store_dwordx2 v[8:9], v4, s[52:55], 0 offen sc1
    s_nop 0
L_RED_END:
    s_endpgm
L_END:
    s_endpgm
.section .rodata,"a"
.p2align 6
.amdhsa_kernel gated_mix__mha_block_cached__geglu_ffn__decode_kernel
  .amdhsa_next_free_vgpr 256
  .amdhsa_next_free_sgpr 102
  .amdhsa_accum_offset 256
  .amdhsa_group_segment_fixed_size 0
  .amdhsa_kernarg_size 104
  .amdhsa_user_sgpr_count 2
  .amdhsa_user_sgpr_kernarg_segment_ptr 1
  .amdhsa_system_sgpr_workgroup_id_x 1
  .amdhsa_float_denorm_mode_32 3
  .amdhsa_float_denorm_mode_16_64 3
.end_amdhsa_kernel
```
